```python
import torch

def _softmax(x, axis=-1):
    return torch.softmax(x, dim=axis)
def _gelu(x):
    return torch.nn.functional.gelu(x, approximate="tanh")
def _silu(x):
    return torch.nn.functional.silu(x)
def _sigmoid(x):
    return torch.sigmoid(x)
def _layernorm(x, axis=-1, eps=1e-5):
    m = x.mean(dim=axis, keepdim=True)
    v = x.var(dim=axis, keepdim=True, unbiased=False)
    return (x - m) / torch.sqrt(v + eps)
def _scatter_add(tgt, idx, src, axis=0):
    return tgt.clone().index_add_(axis, idx, src)
def _segment_sum(src, seg, n):
    out = torch.zeros((n,) + src.shape[1:], dtype=src.dtype)
    return out.index_add_(0, seg, src)
def _pad(x, pw):
    flat = tuple(v for pair in reversed(pw) for v in pair)
    return torch.nn.functional.pad(x, flat)

kernel_name = 'parallel_sum__spectral_gfnet__glu_gated_bilinear__prompt'

def setup_inputs():

    _w = (lambda a: (lambda t: t.to(torch.bfloat16) if t.is_floating_point() else t)(torch.as_tensor(a)))
    def _A_setup():
        B, S, D = 1, 2048, 640
        Df = D // 2 + 1
        return {
            "x": _w((lambda *s: torch.randn(*s, dtype=torch.bfloat16) * 0.05)(B, S, D)),
            "w_r": _w((lambda *s: torch.randn(*s, dtype=torch.bfloat16) * 0.4)(S, Df) * 0.02),
            "w_i": _w((lambda *s: torch.randn(*s, dtype=torch.bfloat16) * 0.4)(S, Df) * 0.02),
        }
    _A_in = _A_setup()

    def _B_setup():
        B, S, D, F = 1, 2048, 640, 1536
        return {
            "x": _w((lambda *s: torch.randn(*s, dtype=torch.bfloat16) * 0.05)(B, S, D)),
            "w_gate": _w((lambda *s: torch.randn(*s, dtype=torch.bfloat16) * 0.2)(D, F) * (D ** -0.5)),
            "w_up": _w((lambda *s: torch.randn(*s, dtype=torch.bfloat16) * 0.2)(D, F) * (D ** -0.5)),
            "w_down": _w((lambda *s: torch.randn(*s, dtype=torch.bfloat16) * 0.2)(F, D) * (F ** -0.5)),
        }
    _B_in = _B_setup()

    return {
        "A_x": _A_in["x"],
        "A_w_r": _A_in["w_r"],
        "A_w_i": _A_in["w_i"],
        "B_x": _B_in["x"],
        "B_w_gate": _B_in["w_gate"],
        "B_w_up": _B_in["w_up"],
        "B_w_down": _B_in["w_down"],
    }

def reference(A_x, A_w_r, A_w_i, B_x, B_w_gate, B_w_up, B_w_down):
    def _A_ref(x, w_r, w_i):
        B, S, D = x.shape
        X = (lambda x, axes=(-2,-1): torch.fft.rfft2(x.float(), dim=axes))(x, axes=(-2, -1))
        W = w_r + 1j * w_i
        X = X * W
        y = (lambda x, s, axes=(-2,-1): torch.fft.irfft2(x, s=s, dim=axes).to(torch.bfloat16))(X, (S, D), axes=(-2, -1))
        return y

    def _B_ref(x, w_gate, w_up, w_down):
        g = torch.einsum("bsd,df->bsf", x, w_gate)
        u = torch.einsum("bsd,df->bsf", x, w_up)
        h = g * u
        return torch.einsum("bsf,fd->bsd", h, w_down)

    x = A_x
    xn = _layernorm(x, axis=-1)
    return x + _A_ref(xn, A_w_r, A_w_i) + _B_ref(xn, B_w_gate, B_w_up, B_w_down)
```

```asm
; @launch grid=(512,1,1) block=(256,1,1) lds=81920
.amdgcn_target "amdgcn-amd-amdhsa--gfx950"
.text
.p2align 8
.globl parallel_sum__spectral_gfnet__glu_gated_bilinear__prompt_kernel
.type parallel_sum__spectral_gfnet__glu_gated_bilinear__prompt_kernel,@function
parallel_sum__spectral_gfnet__glu_gated_bilinear__prompt_kernel:
    s_cmp_ge_u32 s2, 512
    s_cbranch_scc1 L_end_parallel_sum__spectral_gfnet__glu_gated_bilinear__prompt_kernel
    s_load_dwordx4 s[4:7], s[0:1], 0
    s_load_dwordx4 s[12:15], s[0:1], 32
    s_load_dwordx2 s[8:9], s[0:1], 16
    s_load_dwordx4 s[16:19], s[0:1], 48
    s_load_dwordx4 s[20:23], s[0:1], 64
    s_cmp_ge_u32 s2, 64
    s_cbranch_scc1 L_nt_1
    s_getpc_b64 s[84:85]
    s_add_u32 s84, s84, parallel_sum__spectral_gfnet__glu_gated_bilinear__prompt_kernel@rel32@lo+4
    s_addc_u32 s85, s85, parallel_sum__spectral_gfnet__glu_gated_bilinear__prompt_kernel@rel32@hi+12
    s_mov_b32 s86, code_end-parallel_sum__spectral_gfnet__glu_gated_bilinear__prompt_kernel
    s_mov_b32 s87, 0x00020000
    v_lshlrev_b32 v253, 7, v0
    buffer_load_dword v253, v253, s[84:87], 0 offen
L_nt_1:
    v_lshrrev_b32 v1, 6, v0
    s_nop 0
    v_readfirstlane_b32 s3, v1
    v_and_b32 v1, 63, v0
    v_lshlrev_b32 v2, 4, v1
    v_and_b32 v3, 15, v1
    v_lshrrev_b32 v4, 4, v1
    v_mov_b32 v5, 0
    v_lshlrev_b32 v6, 7, v1
    s_mov_b32 s90, s2
    s_and_b32 s2, s2, 255
    s_waitcnt lgkmcnt(0)
    s_mov_b32 s24, s22
    s_mov_b32 s25, s23
    s_mov_b32 s26, 19243008
    s_mov_b32 s27, 0x00020000
    s_mov_b32 s28, s4
    s_mov_b32 s29, s5
    s_mov_b32 s30, 2621440
    s_mov_b32 s31, 0x00020000
    s_mov_b32 s92, s20
    s_mov_b32 s93, s21
    s_mov_b32 s94, 256
    s_mov_b32 s95, 0x00020000
    s_cmp_lt_u32 s90, 256
    s_cbranch_scc1 L_roleA_2
    s_setprio 1
    s_and_b32 s46, s2, 1
    s_lshl_b32 s46, s46, 3
    s_bfe_u32 s48, s2, 0x30003
    s_add_u32 s46, s46, s48
    s_bfe_u32 s47, s2, 0x20001
    s_lshl_b32 s47, s47, 2
    s_lshr_b32 s49, s2, 6
    s_add_u32 s47, s47, s49
    s_mul_i32 s49, s49, 5
    s_lshr_b32 s49, s49, 1
    s_lshr_b32 s40, s48, 2
    s_add_u32 s48, s48, s40
    s_add_u32 s40, s48, s49
    s_cmp_ge_u32 s40, 10
    s_cselect_b32 s48, 10, 0
    s_sub_u32 s43, s40, s48
    s_lshl_b32 s40, s43, 1
    s_and_b32 s50, s3, 1
    s_lshr_b32 s51, s3, 1
    s_cmp_eq_u32 s50, 0
    s_cselect_b32 s36, s12, s14
    s_cselect_b32 s37, s13, s15
    s_mov_b32 s38, 1966080
    s_mov_b32 s39, 0x00020000
    s_mul_i32 s41, s51, 49152
    s_mul_i32 s48, s47, 192
    s_add_u32 s41, s41, s48
    s_lshl_b32 s42, s46, 7
    s_lshl_b32 s48, s3, 5
    s_add_u32 s42, s42, s48
    s_mul_i32 s42, s42, 1280
    s_mul_i32 s44, s3, 3072
    s_lshl_b32 s45, s3, 11
    s_add_u32 s45, s45, 12288
    s_lshl_b32 s49, s50, 1
    v_add_u32 v162, 0, v1
    v_mul_u32_u24 v163, 171, v162
    v_lshrrev_b32 v163, 11, v163
    v_mul_u32_u24 v164, 12, v163
    v_sub_u32 v162, v162, v164
    v_xor_b32 v162, s49, v162
    v_mul_u32_u24 v163, 3072, v163
    v_lshl_add_u32 v156, v162, 4, v163
    v_add_u32 v162, 64, v1
    v_mul_u32_u24 v163, 171, v162
    v_lshrrev_b32 v163, 11, v163
    v_mul_u32_u24 v164, 12, v163
    v_sub_u32 v162, v162, v164
    v_xor_b32 v162, s49, v162
    v_mul_u32_u24 v163, 3072, v163
    v_lshl_add_u32 v157, v162, 4, v163
    v_subrev_u32 v157, 1024, v157
    v_add_u32 v162, 128, v1
    v_mul_u32_u24 v163, 171, v162
    v_lshrrev_b32 v163, 11, v163
    v_mul_u32_u24 v164, 12, v163
    v_sub_u32 v162, v162, v164
    v_xor_b32 v162, s49, v162
    v_mul_u32_u24 v163, 3072, v163
    v_lshl_add_u32 v158, v162, 4, v163
    v_subrev_u32 v158, 2048, v158
    v_lshrrev_b32 v162, 2, v1
    v_and_b32 v163, 3, v1
    v_xor_b32 v163, v163, v4
    v_mul_u32_u24 v162, 1280, v162
    v_lshl_add_u32 v160, v163, 4, v162
    v_add_u32 v161, 19456, v160
    s_lshl_b32 s53, s43, 7
    s_add_u32 s53, s53, s42
    s_add_u32 m0, s45, 0
    s_add_u32 s43, s43, 1
    buffer_load_dwordx4 v160, s[28:31], s53 offen lds
    s_add_u32 m0, s45, 20416
    s_cmp_eq_u32 s43, 10
    buffer_load_dwordx4 v160, s[28:31], s53 offen offset:64 lds
    s_cselect_b32 s43, 0, s43
    s_add_u32 m0, s45, 0
    s_nop 0
    buffer_load_dwordx4 v161, s[28:31], s53 offen offset:1024 lds
    s_add_u32 m0, s45, 20416
    s_nop 0
    buffer_load_dwordx4 v161, s[28:31], s53 offen offset:1088 lds
    s_mul_i32 s52, s40, 98304
    s_add_u32 s52, s52, s41
    s_add_u32 m0, s44, 0
    s_add_u32 s40, s40, 1
    buffer_load_dwordx4 v156, s[36:39], s52 offen lds
    s_cmp_eq_u32 s40, 20
    buffer_load_dwordx4 v157, s[36:39], s52 offen offset:1024 lds
    s_cselect_b32 s40, 0, s40
    buffer_load_dwordx4 v158, s[36:39], s52 offen offset:2048 lds
    v_and_b32 v162, 1, v4
    v_lshrrev_b32 v163, 5, v1
    v_lshrrev_b32 v164, 2, v3
    v_lshl_add_u32 v164, v163, 3, v164
    v_mul_u32_u24 v164, 192, v164
    v_mul_u32_u24 v165, 3072, v162
    v_add_u32 v164, v164, v165
    v_and_b32 v165, 3, v1
    v_lshl_add_u32 v164, v165, 3, v164
    s_mul_i32 s48, s50, 3
    s_add_u32 s49, s48, 0
    v_xor_b32 v165, s49, v162
    v_lshl_add_u32 v144, v165, 5, v164
    v_add_u32 v147, 40960, v144
    s_add_u32 s49, s48, 1
    v_xor_b32 v165, s49, v162
    v_lshl_add_u32 v145, v165, 5, v164
    v_add_u32 v148, 40960, v145
    s_add_u32 s49, s48, 2
    v_xor_b32 v165, s49, v162
    v_lshl_add_u32 v146, v165, 5, v164
    v_add_u32 v149, 40960, v146
    v_and_b32 v164, 31, v1
    v_bfe_u32 v165, v1, 2, 2
    v_xor_b32 v165, v165, v163
    v_lshlrev_b32 v165, 4, v165
    v_lshl_add_u32 v165, v164, 6, v165
    s_lshl_b32 s48, s51, 12
    s_add_u32 s48, s48, 12288
    v_add_u32 v152, s48, v165
    v_xor_b32 v153, 32, v152
    v_add_u32 v154, 40960, v152
    v_add_u32 v155, 40960, v153
    v_mul_u32_u24 v202, 6144, v162
    v_lshl_add_u32 v202, v3, 2, v202
    v_lshlrev_b32 v203, 3, v164
    v_mov_b32 v165, 1073741824
    v_cmp_gt_u32 vcc, 32, v1
    s_nop 1
    v_cndmask_b32 v202, v165, v202, vcc
    v_cndmask_b32 v203, v165, v203, vcc
    s_lshl_b32 s48, s46, 11
    s_lshl_b32 s49, s47, 11
    s_add_u32 s49, s49, 32768
    v_mov_b32 v172, s48
    v_mov_b32 v165, s49
    v_cndmask_b32 v172, v165, v172, vcc
    v_lshl_add_u32 v172, v3, 7, v172
    s_mov_b32 s56, 19013632
    v_mov_b32 v8, 0
    v_mov_b32 v9, 0
    v_mov_b32 v10, 0
    v_mov_b32 v11, 0
    v_mov_b32 v12, 0
    v_mov_b32 v13, 0
    v_mov_b32 v14, 0
    v_mov_b32 v15, 0
    v_mov_b32 v16, 0
    v_mov_b32 v17, 0
    v_mov_b32 v18, 0
    v_mov_b32 v19, 0
    v_mov_b32 v20, 0
    v_mov_b32 v21, 0
    v_mov_b32 v22, 0
    v_mov_b32 v23, 0
    v_mov_b32 v24, 0
    v_mov_b32 v25, 0
    v_mov_b32 v26, 0
    v_mov_b32 v27, 0
    v_mov_b32 v28, 0
    v_mov_b32 v29, 0
    v_mov_b32 v30, 0
    v_mov_b32 v31, 0
    v_mov_b32 v32, 0
    v_mov_b32 v33, 0
    v_mov_b32 v34, 0
    v_mov_b32 v35, 0
    v_mov_b32 v36, 0
    v_mov_b32 v37, 0
    v_mov_b32 v38, 0
    v_mov_b32 v39, 0
    v_mov_b32 v40, 0
    v_mov_b32 v41, 0
    v_mov_b32 v42, 0
    v_mov_b32 v43, 0
    v_mov_b32 v44, 0
    v_mov_b32 v45, 0
    v_mov_b32 v46, 0
    v_mov_b32 v47, 0
    v_mov_b32 v48, 0
    v_mov_b32 v49, 0
    v_mov_b32 v50, 0
    v_mov_b32 v51, 0
    v_mov_b32 v52, 0
    v_mov_b32 v53, 0
    v_mov_b32 v54, 0
    v_mov_b32 v55, 0
    v_mov_b32 v56, 0
    v_mov_b32 v57, 0
    v_mov_b32 v58, 0
    v_mov_b32 v59, 0
    v_mov_b32 v60, 0
    v_mov_b32 v61, 0
    v_mov_b32 v62, 0
    v_mov_b32 v63, 0
    v_mov_b32 v64, 0
    v_mov_b32 v65, 0
    v_mov_b32 v66, 0
    v_mov_b32 v67, 0
    v_mov_b32 v68, 0
    v_mov_b32 v69, 0
    v_mov_b32 v70, 0
    v_mov_b32 v71, 0
    v_mov_b32 v72, 0
    v_mov_b32 v73, 0
    v_mov_b32 v74, 0
    v_mov_b32 v75, 0
    v_mov_b32 v76, 0
    v_mov_b32 v77, 0
    v_mov_b32 v78, 0
    v_mov_b32 v79, 0
    v_mov_b32 v80, 0
    v_mov_b32 v81, 0
    v_mov_b32 v82, 0
    v_mov_b32 v83, 0
    v_mov_b32 v84, 0
    v_mov_b32 v85, 0
    v_mov_b32 v86, 0
    v_mov_b32 v87, 0
    v_mov_b32 v88, 0
    v_mov_b32 v89, 0
    v_mov_b32 v90, 0
    v_mov_b32 v91, 0
    v_mov_b32 v92, 0
    v_mov_b32 v93, 0
    v_mov_b32 v94, 0
    v_mov_b32 v95, 0
    v_mov_b32 v96, 0
    v_mov_b32 v97, 0
    v_mov_b32 v98, 0
    v_mov_b32 v99, 0
    v_mov_b32 v100, 0
    v_mov_b32 v101, 0
    v_mov_b32 v102, 0
    v_mov_b32 v103, 0
    s_mul_i32 s52, s40, 98304
    s_add_u32 s52, s52, s41
    s_add_u32 m0, s44, 20480
    s_add_u32 s40, s40, 1
    buffer_load_dwordx4 v156, s[36:39], s52 offen lds
    s_cmp_eq_u32 s40, 20
    buffer_load_dwordx4 v157, s[36:39], s52 offen offset:1024 lds
    s_cselect_b32 s40, 0, s40
    buffer_load_dwordx4 v158, s[36:39], s52 offen offset:2048 lds
    s_lshl_b32 s53, s43, 7
    s_add_u32 s53, s53, s42
    s_add_u32 m0, s45, 40960
    s_add_u32 s43, s43, 1
    buffer_load_dwordx4 v160, s[28:31], s53 offen lds
    s_add_u32 m0, s45, 61376
    s_cmp_eq_u32 s43, 10
    buffer_load_dwordx4 v160, s[28:31], s53 offen offset:64 lds
    s_cselect_b32 s43, 0, s43
    s_add_u32 m0, s45, 40960
    s_nop 0
    buffer_load_dwordx4 v161, s[28:31], s53 offen offset:1024 lds
    s_add_u32 m0, s45, 61376
    s_nop 0
    buffer_load_dwordx4 v161, s[28:31], s53 offen offset:1088 lds
    s_mul_i32 s52, s40, 98304
    s_add_u32 s52, s52, s41
    s_add_u32 m0, s44, 40960
    s_add_u32 s40, s40, 1
    buffer_load_dwordx4 v156, s[36:39], s52 offen lds
    s_cmp_eq_u32 s40, 20
    buffer_load_dwordx4 v157, s[36:39], s52 offen offset:1024 lds
    s_cselect_b32 s40, 0, s40
    buffer_load_dwordx4 v158, s[36:39], s52 offen offset:2048 lds
    s_waitcnt vmcnt(10)
    s_barrier
    ds_read_b64_tr_b16 v[104:105], v144 offset:0
    ds_read_b64_tr_b16 v[106:107], v144 offset:768
    ds_read_b128 v[116:119], v152 offset:0
    ds_read_b128 v[120:123], v152 offset:2048
    ds_read_b64_tr_b16 v[108:109], v145 offset:0
    ds_read_b64_tr_b16 v[110:111], v145 offset:768
    ds_read_b64_tr_b16 v[112:113], v146 offset:0
    ds_read_b64_tr_b16 v[114:115], v146 offset:768
    s_waitcnt lgkmcnt(0)
    s_mov_b32 s56, 18980864
    s_mov_b32 s55, 0
L_gloop_3:
L_gn3_4:
    v_mfma_f32_32x32x16_bf16 v[8:23], v[104:107], v[116:119], v[8:23]
    ds_read_b64_tr_b16 v[124:125], v144 offset:6144
    ds_read_b64_tr_b16 v[126:127], v144 offset:6912
    ds_read_b128 v[136:139], v153 offset:0
    v_mfma_f32_32x32x16_bf16 v[24:39], v[104:107], v[120:123], v[24:39]
    ds_read_b128 v[140:143], v153 offset:2048
    ds_read_b64_tr_b16 v[128:129], v145 offset:6144
    ds_read_b64_tr_b16 v[130:131], v145 offset:6912
    s_mul_i32 s52, s40, 98304
    s_add_u32 s52, s52, s41
    s_add_u32 m0, s44, 61440
    s_add_u32 s40, s40, 1
    buffer_load_dwordx4 v156, s[36:39], s52 offen lds
    v_mfma_f32_32x32x16_bf16 v[40:55], v[108:111], v[116:119], v[40:55]
    ds_read_b64_tr_b16 v[132:133], v146 offset:6144
    ds_read_b64_tr_b16 v[134:135], v146 offset:6912
    s_cmp_eq_u32 s40, 20
    buffer_load_dwordx4 v157, s[36:39], s52 offen offset:1024 lds
    s_cselect_b32 s40, 0, s40
    v_mfma_f32_32x32x16_bf16 v[56:71], v[108:111], v[120:123], v[56:71]
    buffer_load_dwordx4 v158, s[36:39], s52 offen offset:2048 lds
    v_mfma_f32_32x32x16_bf16 v[72:87], v[112:115], v[116:119], v[72:87]
    s_waitcnt vmcnt(10) lgkmcnt(0)
    s_barrier
    v_mfma_f32_32x32x16_bf16 v[88:103], v[112:115], v[120:123], v[88:103]
    v_mfma_f32_32x32x16_bf16 v[8:23], v[124:127], v[136:139], v[8:23]
    ds_read_b64_tr_b16 v[104:105], v144 offset:20480
    ds_read_b64_tr_b16 v[106:107], v144 offset:21248
    ds_read_b128 v[116:119], v152 offset:20480
    v_mfma_f32_32x32x16_bf16 v[24:39], v[124:127], v[140:143], v[24:39]
    ds_read_b128 v[120:123], v152 offset:22528
    ds_read_b64_tr_b16 v[108:109], v145 offset:20480
    ds_read_b64_tr_b16 v[110:111], v145 offset:21248
    s_mul_i32 s52, s40, 98304
    s_add_u32 s52, s52, s41
    s_add_u32 m0, s44, 0
    s_add_u32 s40, s40, 1
    buffer_load_dwordx4 v156, s[36:39], s52 offen lds
    v_mfma_f32_32x32x16_bf16 v[40:55], v[128:131], v[136:139], v[40:55]
    ds_read_b64_tr_b16 v[112:113], v146 offset:20480
    ds_read_b64_tr_b16 v[114:115], v146 offset:21248
    s_cmp_eq_u32 s40, 20
    buffer_load_dwordx4 v157, s[36:39], s52 offen offset:1024 lds
    s_cselect_b32 s40, 0, s40
    v_mfma_f32_32x32x16_bf16 v[56:71], v[128:131], v[140:143], v[56:71]
    buffer_load_dwordx4 v158, s[36:39], s52 offen offset:2048 lds
    v_mfma_f32_32x32x16_bf16 v[72:87], v[132:135], v[136:139], v[72:87]
    s_waitcnt lgkmcnt(0)
    v_mfma_f32_32x32x16_bf16 v[88:103], v[132:135], v[140:143], v[88:103]
    v_mfma_f32_32x32x16_bf16 v[8:23], v[104:107], v[116:119], v[8:23]
    ds_read_b64_tr_b16 v[124:125], v144 offset:26624
    ds_read_b64_tr_b16 v[126:127], v144 offset:27392
    ds_read_b128 v[136:139], v153 offset:20480
    v_mfma_f32_32x32x16_bf16 v[24:39], v[104:107], v[120:123], v[24:39]
    ds_read_b128 v[140:143], v153 offset:22528
    ds_read_b64_tr_b16 v[128:129], v145 offset:26624
    ds_read_b64_tr_b16 v[130:131], v145 offset:27392
    v_mfma_f32_32x32x16_bf16 v[40:55], v[108:111], v[116:119], v[40:55]
    ds_read_b64_tr_b16 v[132:133], v146 offset:26624
    ds_read_b64_tr_b16 v[134:135], v146 offset:27392
    v_mfma_f32_32x32x16_bf16 v[56:71], v[108:111], v[120:123], v[56:71]
    v_mfma_f32_32x32x16_bf16 v[72:87], v[112:115], v[116:119], v[72:87]
    s_waitcnt vmcnt(6) lgkmcnt(0)
    s_barrier
    v_mfma_f32_32x32x16_bf16 v[88:103], v[112:115], v[120:123], v[88:103]
    v_mfma_f32_32x32x16_bf16 v[8:23], v[124:127], v[136:139], v[8:23]
    ds_read_b64_tr_b16 v[104:105], v147 offset:0
    ds_read_b64_tr_b16 v[106:107], v147 offset:768
    ds_read_b128 v[116:119], v154 offset:0
    v_mfma_f32_32x32x16_bf16 v[24:39], v[124:127], v[140:143], v[24:39]
    ds_read_b128 v[120:123], v154 offset:2048
    ds_read_b64_tr_b16 v[108:109], v148 offset:0
    ds_read_b64_tr_b16 v[110:111], v148 offset:768
    s_lshl_b32 s53, s43, 7
    s_add_u32 s53, s53, s42
    s_add_u32 m0, s45, 0
    s_add_u32 s43, s43, 1
    buffer_load_dwordx4 v160, s[28:31], s53 offen lds
    v_mfma_f32_32x32x16_bf16 v[40:55], v[128:131], v[136:139], v[40:55]
    ds_read_b64_tr_b16 v[112:113], v149 offset:0
    ds_read_b64_tr_b16 v[114:115], v149 offset:768
    s_add_u32 m0, s45, 20416
    s_cmp_eq_u32 s43, 10
    buffer_load_dwordx4 v160, s[28:31], s53 offen offset:64 lds
    s_cselect_b32 s43, 0, s43
    v_mfma_f32_32x32x16_bf16 v[56:71], v[128:131], v[140:143], v[56:71]
    s_add_u32 m0, s45, 0
    s_nop 0
    buffer_load_dwordx4 v161, s[28:31], s53 offen offset:1024 lds
    v_mfma_f32_32x32x16_bf16 v[72:87], v[132:135], v[136:139], v[72:87]
    s_waitcnt lgkmcnt(0)
    v_mfma_f32_32x32x16_bf16 v[88:103], v[132:135], v[140:143], v[88:103]
    s_add_u32 m0, s45, 20416
    s_nop 0
    buffer_load_dwordx4 v161, s[28:31], s53 offen offset:1088 lds
    v_mfma_f32_32x32x16_bf16 v[8:23], v[104:107], v[116:119], v[8:23]
    ds_read_b64_tr_b16 v[124:125], v147 offset:6144
    ds_read_b64_tr_b16 v[126:127], v147 offset:6912
    ds_read_b128 v[136:139], v155 offset:0
    v_mfma_f32_32x32x16_bf16 v[24:39], v[104:107], v[120:123], v[24:39]
    ds_read_b128 v[140:143], v155 offset:2048
    ds_read_b64_tr_b16 v[128:129], v148 offset:6144
    ds_read_b64_tr_b16 v[130:131], v148 offset:6912
    s_mul_i32 s52, s40, 98304
    s_add_u32 s52, s52, s41
    s_add_u32 m0, s44, 20480
    s_add_u32 s40, s40, 1
    buffer_load_dwordx4 v156, s[36:39], s52 offen lds
    v_mfma_f32_32x32x16_bf16 v[40:55], v[108:111], v[116:119], v[40:55]
    ds_read_b64_tr_b16 v[132:133], v149 offset:6144
    ds_read_b64_tr_b16 v[134:135], v149 offset:6912
    s_cmp_eq_u32 s40, 20
    buffer_load_dwordx4 v157, s[36:39], s52 offen offset:1024 lds
    s_cselect_b32 s40, 0, s40
    v_mfma_f32_32x32x16_bf16 v[56:71], v[108:111], v[120:123], v[56:71]
    buffer_load_dwordx4 v158, s[36:39], s52 offen offset:2048 lds
    v_mfma_f32_32x32x16_bf16 v[72:87], v[112:115], v[116:119], v[72:87]
    s_waitcnt vmcnt(10) lgkmcnt(0)
    s_barrier
    v_mfma_f32_32x32x16_bf16 v[88:103], v[112:115], v[120:123], v[88:103]
    v_mfma_f32_32x32x16_bf16 v[8:23], v[124:127], v[136:139], v[8:23]
    ds_read_b64_tr_b16 v[104:105], v147 offset:20480
    ds_read_b64_tr_b16 v[106:107], v147 offset:21248
    ds_read_b128 v[116:119], v154 offset:20480
    v_mfma_f32_32x32x16_bf16 v[24:39], v[124:127], v[140:143], v[24:39]
    ds_read_b128 v[120:123], v154 offset:22528
    ds_read_b64_tr_b16 v[108:109], v148 offset:20480
    ds_read_b64_tr_b16 v[110:111], v148 offset:21248
    s_mul_i32 s52, s40, 98304
    s_add_u32 s52, s52, s41
    s_add_u32 m0, s44, 40960
    s_add_u32 s40, s40, 1
    buffer_load_dwordx4 v156, s[36:39], s52 offen lds
    v_mfma_f32_32x32x16_bf16 v[40:55], v[128:131], v[136:139], v[40:55]
    ds_read_b64_tr_b16 v[112:113], v149 offset:20480
    ds_read_b64_tr_b16 v[114:115], v149 offset:21248
    s_cmp_eq_u32 s40, 20
    buffer_load_dwordx4 v157, s[36:39], s52 offen offset:1024 lds
    s_cselect_b32 s40, 0, s40
    v_mfma_f32_32x32x16_bf16 v[56:71], v[128:131], v[140:143], v[56:71]
    buffer_load_dwordx4 v158, s[36:39], s52 offen offset:2048 lds
    v_mfma_f32_32x32x16_bf16 v[72:87], v[132:135], v[136:139], v[72:87]
    s_waitcnt lgkmcnt(0)
    v_mfma_f32_32x32x16_bf16 v[88:103], v[132:135], v[140:143], v[88:103]
    v_mfma_f32_32x32x16_bf16 v[8:23], v[104:107], v[116:119], v[8:23]
    ds_read_b64_tr_b16 v[124:125], v147 offset:26624
    ds_read_b64_tr_b16 v[126:127], v147 offset:27392
    ds_read_b128 v[136:139], v155 offset:20480
    v_mfma_f32_32x32x16_bf16 v[24:39], v[104:107], v[120:123], v[24:39]
    ds_read_b128 v[140:143], v155 offset:22528
    ds_read_b64_tr_b16 v[128:129], v148 offset:26624
    ds_read_b64_tr_b16 v[130:131], v148 offset:27392
    v_mfma_f32_32x32x16_bf16 v[40:55], v[108:111], v[116:119], v[40:55]
    ds_read_b64_tr_b16 v[132:133], v149 offset:26624
    ds_read_b64_tr_b16 v[134:135], v149 offset:27392
    v_mfma_f32_32x32x16_bf16 v[56:71], v[108:111], v[120:123], v[56:71]
    v_mfma_f32_32x32x16_bf16 v[72:87], v[112:115], v[116:119], v[72:87]
    s_waitcnt vmcnt(6) lgkmcnt(0)
    s_barrier
    v_mfma_f32_32x32x16_bf16 v[88:103], v[112:115], v[120:123], v[88:103]
    v_mfma_f32_32x32x16_bf16 v[8:23], v[124:127], v[136:139], v[8:23]
    ds_read_b64_tr_b16 v[104:105], v144 offset:0
    ds_read_b64_tr_b16 v[106:107], v144 offset:768
    ds_read_b128 v[116:119], v152 offset:0
    v_mfma_f32_32x32x16_bf16 v[24:39], v[124:127], v[140:143], v[24:39]
    ds_read_b128 v[120:123], v152 offset:2048
    ds_read_b64_tr_b16 v[108:109], v145 offset:0
    ds_read_b64_tr_b16 v[110:111], v145 offset:768
    s_lshl_b32 s53, s43, 7
    s_add_u32 s53, s53, s42
    s_add_u32 m0, s45, 40960
    s_add_u32 s43, s43, 1
    buffer_load_dwordx4 v160, s[28:31], s53 offen lds
    v_mfma_f32_32x32x16_bf16 v[40:55], v[128:131], v[136:139], v[40:55]
    ds_read_b64_tr_b16 v[112:113], v146 offset:0
    ds_read_b64_tr_b16 v[114:115], v146 offset:768
    s_add_u32 m0, s45, 61376
    s_cmp_eq_u32 s43, 10
    buffer_load_dwordx4 v160, s[28:31], s53 offen offset:64 lds
    s_cselect_b32 s43, 0, s43
    v_mfma_f32_32x32x16_bf16 v[56:71], v[128:131], v[140:143], v[56:71]
    s_add_u32 m0, s45, 40960
    s_nop 0
    buffer_load_dwordx4 v161, s[28:31], s53 offen offset:1024 lds
    v_mfma_f32_32x32x16_bf16 v[72:87], v[132:135], v[136:139], v[72:87]
    s_waitcnt lgkmcnt(0)
    v_mfma_f32_32x32x16_bf16 v[88:103], v[132:135], v[140:143], v[88:103]
    s_add_u32 m0, s45, 61376
    s_nop 0
    buffer_load_dwordx4 v161, s[28:31], s53 offen offset:1088 lds
    s_add_u32 s55, s55, 1
    s_cmp_lt_u32 s55, 4
    s_cbranch_scc1 L_gloop_3
    v_mfma_f32_32x32x16_bf16 v[8:23], v[104:107], v[116:119], v[8:23]
    ds_read_b64_tr_b16 v[124:125], v144 offset:6144
    ds_read_b64_tr_b16 v[126:127], v144 offset:6912
    ds_read_b128 v[136:139], v153 offset:0
    v_mfma_f32_32x32x16_bf16 v[24:39], v[104:107], v[120:123], v[24:39]
    ds_read_b128 v[140:143], v153 offset:2048
    ds_read_b64_tr_b16 v[128:129], v145 offset:6144
    ds_read_b64_tr_b16 v[130:131], v145 offset:6912
    s_mul_i32 s52, s40, 98304
    s_add_u32 s52, s52, s41
    s_add_u32 m0, s44, 61440
    s_add_u32 s40, s40, 1
    buffer_load_dwordx4 v156, s[36:39], s52 offen lds
    v_mfma_f32_32x32x16_bf16 v[40:55], v[108:111], v[116:119], v[40:55]
    ds_read_b64_tr_b16 v[132:133], v146 offset:6144
    ds_read_b64_tr_b16 v[134:135], v146 offset:6912
    s_cmp_eq_u32 s40, 20
    buffer_load_dwordx4 v157, s[36:39], s52 offen offset:1024 lds
    s_cselect_b32 s40, 0, s40
    v_mfma_f32_32x32x16_bf16 v[56:71], v[108:111], v[120:123], v[56:71]
    buffer_load_dwordx4 v158, s[36:39], s52 offen offset:2048 lds
    v_mfma_f32_32x32x16_bf16 v[72:87], v[112:115], v[116:119], v[72:87]
    s_waitcnt vmcnt(10) lgkmcnt(0)
    s_barrier
    v_mfma_f32_32x32x16_bf16 v[88:103], v[112:115], v[120:123], v[88:103]
    v_mfma_f32_32x32x16_bf16 v[8:23], v[124:127], v[136:139], v[8:23]
    ds_read_b64_tr_b16 v[104:105], v144 offset:20480
    ds_read_b64_tr_b16 v[106:107], v144 offset:21248
    ds_read_b128 v[116:119], v152 offset:20480
    v_mfma_f32_32x32x16_bf16 v[24:39], v[124:127], v[140:143], v[24:39]
    ds_read_b128 v[120:123], v152 offset:22528
    ds_read_b64_tr_b16 v[108:109], v145 offset:20480
    ds_read_b64_tr_b16 v[110:111], v145 offset:21248
    v_mfma_f32_32x32x16_bf16 v[40:55], v[128:131], v[136:139], v[40:55]
    ds_read_b64_tr_b16 v[112:113], v146 offset:20480
    ds_read_b64_tr_b16 v[114:115], v146 offset:21248
    v_mfma_f32_32x32x16_bf16 v[56:71], v[128:131], v[140:143], v[56:71]
    v_mfma_f32_32x32x16_bf16 v[72:87], v[132:135], v[136:139], v[72:87]
    s_waitcnt lgkmcnt(0)
    v_mfma_f32_32x32x16_bf16 v[88:103], v[132:135], v[140:143], v[88:103]
    s_cmp_eq_u32 s3, 0
    s_cselect_b32 s57, 0, 1073741824
    s_cselect_b32 s58, s56, 1073741824
    buffer_load_dword v166, v5, s[92:95], s57 offen sc1
    buffer_load_dword v168, v6, s[24:27], s58 offen sc1
    s_add_u32 s91, s58, 8192
    buffer_load_dword v169, v6, s[24:27], s91 offen sc1
    s_add_u32 s91, s58, 16384
    buffer_load_dword v170, v6, s[24:27], s91 offen sc1
    s_add_u32 s91, s58, 24576
    buffer_load_dword v171, v6, s[24:27], s91 offen sc1
    v_mfma_f32_32x32x16_bf16 v[8:23], v[104:107], v[116:119], v[8:23]
    ds_read_b64_tr_b16 v[124:125], v144 offset:26624
    ds_read_b64_tr_b16 v[126:127], v144 offset:27392
    ds_read_b128 v[136:139], v153 offset:20480
    v_mfma_f32_32x32x16_bf16 v[24:39], v[104:107], v[120:123], v[24:39]
    ds_read_b128 v[140:143], v153 offset:22528
    ds_read_b64_tr_b16 v[128:129], v145 offset:26624
    ds_read_b64_tr_b16 v[130:131], v145 offset:27392
    v_mfma_f32_32x32x16_bf16 v[40:55], v[108:111], v[116:119], v[40:55]
    ds_read_b64_tr_b16 v[132:133], v146 offset:26624
    ds_read_b64_tr_b16 v[134:135], v146 offset:27392
    v_mfma_f32_32x32x16_bf16 v[56:71], v[108:111], v[120:123], v[56:71]
    v_mfma_f32_32x32x16_bf16 v[72:87], v[112:115], v[116:119], v[72:87]
    s_waitcnt vmcnt(8) lgkmcnt(0)
    s_barrier
    v_mfma_f32_32x32x16_bf16 v[88:103], v[112:115], v[120:123], v[88:103]
    v_mfma_f32_32x32x16_bf16 v[8:23], v[124:127], v[136:139], v[8:23]
    ds_read_b64_tr_b16 v[104:105], v147 offset:0
    ds_read_b64_tr_b16 v[106:107], v147 offset:768
    ds_read_b128 v[116:119], v154 offset:0
    v_mfma_f32_32x32x16_bf16 v[24:39], v[124:127], v[140:143], v[24:39]
    ds_read_b128 v[120:123], v154 offset:2048
    ds_read_b64_tr_b16 v[108:109], v148 offset:0
    ds_read_b64_tr_b16 v[110:111], v148 offset:768
    v_mfma_f32_32x32x16_bf16 v[40:55], v[128:131], v[136:139], v[40:55]
    ds_read_b64_tr_b16 v[112:113], v149 offset:0
    ds_read_b64_tr_b16 v[114:115], v149 offset:768
    v_mfma_f32_32x32x16_bf16 v[56:71], v[128:131], v[140:143], v[56:71]
    v_mfma_f32_32x32x16_bf16 v[72:87], v[132:135], v[136:139], v[72:87]
    s_waitcnt lgkmcnt(0)
    v_mfma_f32_32x32x16_bf16 v[88:103], v[132:135], v[140:143], v[88:103]
    v_mfma_f32_32x32x16_bf16 v[8:23], v[104:107], v[116:119], v[8:23]
    ds_read_b64_tr_b16 v[124:125], v147 offset:6144
    ds_read_b64_tr_b16 v[126:127], v147 offset:6912
    ds_read_b128 v[136:139], v155 offset:0
    v_mfma_f32_32x32x16_bf16 v[24:39], v[104:107], v[120:123], v[24:39]
    ds_read_b128 v[140:143], v155 offset:2048
    ds_read_b64_tr_b16 v[128:129], v148 offset:6144
    ds_read_b64_tr_b16 v[130:131], v148 offset:6912
    v_mfma_f32_32x32x16_bf16 v[40:55], v[108:111], v[116:119], v[40:55]
    ds_read_b64_tr_b16 v[132:133], v149 offset:6144
    ds_read_b64_tr_b16 v[134:135], v149 offset:6912
    v_mfma_f32_32x32x16_bf16 v[56:71], v[108:111], v[120:123], v[56:71]
    v_mfma_f32_32x32x16_bf16 v[72:87], v[112:115], v[116:119], v[72:87]
    s_waitcnt vmcnt(0)
    s_cmp_eq_u32 s3, 0
    s_cbranch_scc0 L_gp_5
    s_mov_b32 s89, 0
    s_nop 7
L_eg_6:
    v_readfirstlane_b32 s88, v166
    s_nop 1
    s_cmp_lg_u32 s88, 0
    s_cbranch_scc1 L_ed_7
    s_add_u32 s89, s89, 1
    s_cmp_gt_u32 s89, 20000
    s_cbranch_scc1 L_ed_7
    s_sleep 8
    buffer_load_dword v166, v5, s[92:95], 0 offen sc1
    s_waitcnt vmcnt(0)
    s_branch L_eg_6
    s_nop 0
L_ed_7:
    s_mov_b32 s89, 0
    s_nop 0
L_fw_8:
    v_cmp_ne_u32 s[32:33], s88, v168
    v_cmp_ne_u32 s[34:35], s88, v169
    v_cmp_ne_u32 s[10:11], s88, v170
    v_cmp_ne_u32 s[96:97], s88, v171
    s_or_b64 vcc, s[32:33], s[34:35]
    s_or_b64 vcc, vcc, s[10:11]
    s_or_b64 vcc, vcc, s[96:97]
    s_cmp_eq_u64 vcc, 0
    s_cbranch_scc1 L_fd_9
    s_add_u32 s89, s89, 1
    s_cmp_gt_u32 s89, 40000
    s_cbranch_scc1 L_fd_9
    s_sleep 6
    s_add_u32 s91, s56, 0
    s_mov_b64 exec, s[32:33]
    s_cbranch_execz L_fk_10
    buffer_load_dword v168, v6, s[24:27], s91 offen sc1
L_fk_10:
    s_add_u32 s91, s56, 8192
    s_mov_b64 exec, s[34:35]
    s_cbranch_execz L_fk_11
    buffer_load_dword v169, v6, s[24:27], s91 offen sc1
L_fk_11:
    s_add_u32 s91, s56, 16384
    s_mov_b64 exec, s[10:11]
    s_cbranch_execz L_fk_12
    buffer_load_dword v170, v6, s[24:27], s91 offen sc1
L_fk_12:
    s_add_u32 s91, s56, 24576
    s_mov_b64 exec, s[96:97]
    s_cbranch_execz L_fk_13
    buffer_load_dword v171, v6, s[24:27], s91 offen sc1
L_fk_13:
    s_mov_b64 exec, -1
    s_waitcnt vmcnt(0)
    s_branch L_fw_8
    s_nop 0
L_fd_9:
L_gp_5:
    s_waitcnt vmcnt(0) lgkmcnt(0)
    s_barrier
    v_mfma_f32_32x32x16_bf16 v[88:103], v[112:115], v[120:123], v[88:103]
    v_mfma_f32_32x32x16_bf16 v[8:23], v[124:127], v[136:139], v[8:23]
    ds_read_b64_tr_b16 v[104:105], v147 offset:20480
    ds_read_b64_tr_b16 v[106:107], v147 offset:21248
    ds_read_b128 v[116:119], v154 offset:20480
    v_mfma_f32_32x32x16_bf16 v[24:39], v[124:127], v[140:143], v[24:39]
    ds_read_b128 v[120:123], v154 offset:22528
    ds_read_b64_tr_b16 v[108:109], v148 offset:20480
    ds_read_b64_tr_b16 v[110:111], v148 offset:21248
    v_mfma_f32_32x32x16_bf16 v[40:55], v[128:131], v[136:139], v[40:55]
    ds_read_b64_tr_b16 v[112:113], v149 offset:20480
    ds_read_b64_tr_b16 v[114:115], v149 offset:21248
    v_mfma_f32_32x32x16_bf16 v[56:71], v[128:131], v[140:143], v[56:71]
    v_mfma_f32_32x32x16_bf16 v[72:87], v[132:135], v[136:139], v[72:87]
    s_waitcnt lgkmcnt(0)
    v_mfma_f32_32x32x16_bf16 v[88:103], v[132:135], v[140:143], v[88:103]
    s_mul_i32 s57, s47, 384
    s_mul_i32 s58, s50, 192
    s_add_u32 s57, s57, s58
    s_add_u32 s57, s57, 18866176
    s_lshl_b32 s58, s46, 10
    s_lshl_b32 s59, s51, 9
    s_add_u32 s58, s58, s59
    s_add_u32 s58, s58, 18964480
    buffer_load_dword v200, v203, s[24:27], s58 offen sc1
    buffer_load_dword v201, v203, s[24:27], s58 offen offset:256 sc1
    buffer_load_dword v176, v202, s[24:27], s57 offen offset:0 sc1
    buffer_load_dword v177, v202, s[24:27], s57 offen offset:64 sc1
    buffer_load_dword v178, v202, s[24:27], s57 offen offset:128 sc1
    s_add_u32 s57, s57, 12288
    buffer_load_dword v179, v202, s[24:27], s57 offen offset:0 sc1
    buffer_load_dword v180, v202, s[24:27], s57 offen offset:64 sc1
    buffer_load_dword v181, v202, s[24:27], s57 offen offset:128 sc1
    s_add_u32 s57, s57, 12288
    buffer_load_dword v182, v202, s[24:27], s57 offen offset:0 sc1
    buffer_load_dword v183, v202, s[24:27], s57 offen offset:64 sc1
    buffer_load_dword v184, v202, s[24:27], s57 offen offset:128 sc1
    s_add_u32 s57, s57, 12288
    buffer_load_dword v185, v202, s[24:27], s57 offen offset:0 sc1
    buffer_load_dword v186, v202, s[24:27], s57 offen offset:64 sc1
    buffer_load_dword v187, v202, s[24:27], s57 offen offset:128 sc1
    s_add_u32 s57, s57, 12288
    buffer_load_dword v188, v202, s[24:27], s57 offen offset:0 sc1
    buffer_load_dword v189, v202, s[24:27], s57 offen offset:64 sc1
    buffer_load_dword v190, v202, s[24:27], s57 offen offset:128 sc1
    s_add_u32 s57, s57, 12288
    buffer_load_dword v191, v202, s[24:27], s57 offen offset:0 sc1
    buffer_load_dword v192, v202, s[24:27], s57 offen offset:64 sc1
    buffer_load_dword v193, v202, s[24:27], s57 offen offset:128 sc1
    s_add_u32 s57, s57, 12288
    buffer_load_dword v194, v202, s[24:27], s57 offen offset:0 sc1
    buffer_load_dword v195, v202, s[24:27], s57 offen offset:64 sc1
    buffer_load_dword v196, v202, s[24:27], s57 offen offset:128 sc1
    s_add_u32 s57, s57, 12288
    buffer_load_dword v197, v202, s[24:27], s57 offen offset:0 sc1
    buffer_load_dword v198, v202, s[24:27], s57 offen offset:64 sc1
    buffer_load_dword v199, v202, s[24:27], s57 offen offset:128 sc1
    s_add_u32 s57, s57, 12288
    s_bfe_u32 s57, s2, 0x10002
    s_mul_i32 s57, s57, 983040
    s_lshr_b32 s58, s2, 3
    s_mul_i32 s58, s58, 30720
    s_add_u32 s57, s57, s58
    s_add_u32 s57, s57, 0
    v_lshlrev_b32 v253, 7, v0
    buffer_load_dword v253, v253, s[24:27], s57 offen sc1
    v_mfma_f32_32x32x16_bf16 v[8:23], v[104:107], v[116:119], v[8:23]
    ds_read_b64_tr_b16 v[124:125], v147 offset:26624
    ds_read_b64_tr_b16 v[126:127], v147 offset:27392
    ds_read_b128 v[136:139], v155 offset:20480
    v_mfma_f32_32x32x16_bf16 v[24:39], v[104:107], v[120:123], v[24:39]
    ds_read_b128 v[140:143], v155 offset:22528
    ds_read_b64_tr_b16 v[128:129], v148 offset:26624
    ds_read_b64_tr_b16 v[130:131], v148 offset:27392
    v_mfma_f32_32x32x16_bf16 v[40:55], v[108:111], v[116:119], v[40:55]
    ds_read_b64_tr_b16 v[132:133], v149 offset:26624
    ds_read_b64_tr_b16 v[134:135], v149 offset:27392
    v_mfma_f32_32x32x16_bf16 v[56:71], v[108:111], v[120:123], v[56:71]
    v_mfma_f32_32x32x16_bf16 v[72:87], v[112:115], v[116:119], v[72:87]
    s_waitcnt lgkmcnt(0)
    v_mfma_f32_32x32x16_bf16 v[88:103], v[112:115], v[120:123], v[88:103]
    v_mfma_f32_32x32x16_bf16 v[8:23], v[124:127], v[136:139], v[8:23]
    s_waitcnt vmcnt(1)
    v_add_f32 v176, v176, v179
    v_add_f32 v176, v176, v182
    v_add_f32 v176, v176, v185
    v_add_f32 v176, v176, v188
    v_add_f32 v176, v176, v191
    v_add_f32 v176, v176, v194
    v_add_f32 v176, v176, v197
    v_cvt_pk_bf16_f32 v104, v176, v176
    v_lshlrev_b32 v162, 16, v104
    v_sub_f32 v162, v176, v162
    v_cvt_pk_bf16_f32 v105, v162, v5
    v_mov_b32 v106, 0
    v_mov_b32 v107, 0
    v_add_f32 v177, v177, v180
    v_mfma_f32_32x32x16_bf16 v[24:39], v[124:127], v[140:143], v[24:39]
    v_add_f32 v177, v177, v183
    v_add_f32 v177, v177, v186
    v_add_f32 v177, v177, v189
    v_add_f32 v177, v177, v192
    v_add_f32 v177, v177, v195
    v_add_f32 v177, v177, v198
    v_cvt_pk_bf16_f32 v108, v177, v177
    v_lshlrev_b32 v162, 16, v108
    v_sub_f32 v162, v177, v162
    v_cvt_pk_bf16_f32 v109, v162, v5
    v_mov_b32 v110, 0
    v_mov_b32 v111, 0
    v_add_f32 v178, v178, v181
    v_add_f32 v178, v178, v184
    v_mfma_f32_32x32x16_bf16 v[40:55], v[128:131], v[136:139], v[40:55]
    v_add_f32 v178, v178, v187
    v_add_f32 v178, v178, v190
    v_add_f32 v178, v178, v193
    v_add_f32 v178, v178, v196
    v_add_f32 v178, v178, v199
    v_cvt_pk_bf16_f32 v112, v178, v178
    v_lshlrev_b32 v162, 16, v112
    v_sub_f32 v162, v178, v162
    v_cvt_pk_bf16_f32 v113, v162, v5
    v_mov_b32 v114, 0
    v_mov_b32 v115, 0
    v_cvt_pk_bf16_f32 v117, -v200, v5
    v_lshlrev_b32 v162, 16, v117
    v_add_f32 v162, v200, v162
    v_mfma_f32_32x32x16_bf16 v[56:71], v[128:131], v[140:143], v[56:71]
    v_cvt_pk_bf16_f32 v116, -v200, -v162
    v_mov_b32 v118, 0
    v_mov_b32 v119, 0
    v_cvt_pk_bf16_f32 v121, -v201, v5
    v_lshlrev_b32 v162, 16, v121
    v_add_f32 v162, v201, v162
    v_cvt_pk_bf16_f32 v120, -v201, -v162
    v_mov_b32 v122, 0
    v_mov_b32 v123, 0
    s_lshl_b32 s54, s46, 1
    s_add_u32 s54, s54, s51
    s_mul_i32 s54, s54, 196608
    s_add_u32 s54, s54, 1966080
    s_mul_i32 s55, s47, 6
    v_mfma_f32_32x32x16_bf16 v[72:87], v[132:135], v[136:139], v[72:87]
    s_mul_i32 s56, s50, 3
    s_add_u32 s55, s55, s56
    v_lshlrev_b32 v164, 4, v3
    v_bfe_u32 v165, v1, 4, 1
    v_lshl_add_u32 v164, v165, 10, v164
    v_lshrrev_b32 v165, 5, v1
    v_lshl_add_u32 v164, v165, 8, v164
    s_add_u32 s56, s55, 0
    s_lshr_b32 s57, s56, 1
    s_lshl_b32 s57, s57, 12
    s_and_b32 s56, s56, 1
    s_lshl_b32 s56, s56, 9
    s_add_u32 s57, s57, s56
    s_add_u32 s58, s57, s54
    v_mfma_f32_32x32x16_bf16 v[88:103], v[132:135], v[140:143], v[88:103]
    s_add_u32 s56, s55, 1
    s_lshr_b32 s57, s56, 1
    s_lshl_b32 s57, s57, 12
    s_and_b32 s56, s56, 1
    s_lshl_b32 s56, s56, 9
    s_add_u32 s57, s57, s56
    s_add_u32 s59, s57, s54
    s_add_u32 s56, s55, 2
    s_lshr_b32 s57, s56, 1
    s_lshl_b32 s57, s57, 12
    s_and_b32 s56, s56, 1
    s_lshl_b32 s56, s56, 9
    s_add_u32 s57, s57, s56
    s_add_u32 s60, s57, s54
    v_mfma_f32_32x32x16_bf16 v[8:23], v[104:107], v[116:119], v[8:23]
    v_mfma_f32_32x32x16_bf16 v[24:39], v[104:107], v[120:123], v[24:39]
    v_mfma_f32_32x32x16_bf16 v[40:55], v[108:111], v[116:119], v[40:55]
    v_mfma_f32_32x32x16_bf16 v[56:71], v[108:111], v[120:123], v[56:71]
    v_mfma_f32_32x32x16_bf16 v[72:87], v[112:115], v[116:119], v[72:87]
    v_mfma_f32_32x32x16_bf16 v[88:103], v[112:115], v[120:123], v[88:103]
    s_nop 6
    v_mul_f32 v8, v8, v16
    v_mul_f32 v9, v9, v17
    v_mul_f32 v10, v10, v18
    v_mul_f32 v11, v11, v19
    v_mul_f32 v12, v12, v20
    v_mul_f32 v13, v13, v21
    v_mul_f32 v14, v14, v22
    v_mul_f32 v15, v15, v23
    v_cvt_pk_bf16_f32 v16, v8, v9
    v_cvt_pk_bf16_f32 v17, v10, v11
    v_cvt_pk_bf16_f32 v18, v12, v13
    v_cvt_pk_bf16_f32 v19, v14, v15
    buffer_store_dwordx4 v[16:19], v164, s[24:27], s58 offen offset:0 sc1
    v_mul_f32 v24, v24, v32
    v_mul_f32 v25, v25, v33
    v_mul_f32 v26, v26, v34
    v_mul_f32 v27, v27, v35
    v_mul_f32 v28, v28, v36
    v_mul_f32 v29, v29, v37
    v_mul_f32 v30, v30, v38
    v_mul_f32 v31, v31, v39
    v_cvt_pk_bf16_f32 v32, v24, v25
    v_cvt_pk_bf16_f32 v33, v26, v27
    v_cvt_pk_bf16_f32 v34, v28, v29
    v_cvt_pk_bf16_f32 v35, v30, v31
    buffer_store_dwordx4 v[32:35], v164, s[24:27], s58 offen offset:2048 sc1
    v_mul_f32 v40, v40, v48
    v_mul_f32 v41, v41, v49
    v_mul_f32 v42, v42, v50
    v_mul_f32 v43, v43, v51
    v_mul_f32 v44, v44, v52
    v_mul_f32 v45, v45, v53
    v_mul_f32 v46, v46, v54
    v_mul_f32 v47, v47, v55
    v_cvt_pk_bf16_f32 v48, v40, v41
    v_cvt_pk_bf16_f32 v49, v42, v43
    v_cvt_pk_bf16_f32 v50, v44, v45
    v_cvt_pk_bf16_f32 v51, v46, v47
    buffer_store_dwordx4 v[48:51], v164, s[24:27], s59 offen offset:0 sc1
    v_mul_f32 v56, v56, v64
    v_mul_f32 v57, v57, v65
    v_mul_f32 v58, v58, v66
    v_mul_f32 v59, v59, v67
    v_mul_f32 v60, v60, v68
    v_mul_f32 v61, v61, v69
    v_mul_f32 v62, v62, v70
    v_mul_f32 v63, v63, v71
    v_cvt_pk_bf16_f32 v64, v56, v57
    v_cvt_pk_bf16_f32 v65, v58, v59
    v_cvt_pk_bf16_f32 v66, v60, v61
    v_cvt_pk_bf16_f32 v67, v62, v63
    buffer_store_dwordx4 v[64:67], v164, s[24:27], s59 offen offset:2048 sc1
    v_mul_f32 v72, v72, v80
    v_mul_f32 v73, v73, v81
    v_mul_f32 v74, v74, v82
    v_mul_f32 v75, v75, v83
    v_mul_f32 v76, v76, v84
    v_mul_f32 v77, v77, v85
    v_mul_f32 v78, v78, v86
    v_mul_f32 v79, v79, v87
    v_cvt_pk_bf16_f32 v80, v72, v73
    v_cvt_pk_bf16_f32 v81, v74, v75
    v_cvt_pk_bf16_f32 v82, v76, v77
    v_cvt_pk_bf16_f32 v83, v78, v79
    buffer_store_dwordx4 v[80:83], v164, s[24:27], s60 offen offset:0 sc1
    v_mul_f32 v88, v88, v96
    v_mul_f32 v89, v89, v97
    v_mul_f32 v90, v90, v98
    v_mul_f32 v91, v91, v99
    v_mul_f32 v92, v92, v100
    v_mul_f32 v93, v93, v101
    v_mul_f32 v94, v94, v102
    v_mul_f32 v95, v95, v103
    v_cvt_pk_bf16_f32 v96, v88, v89
    v_cvt_pk_bf16_f32 v97, v90, v91
    v_cvt_pk_bf16_f32 v98, v92, v93
    v_cvt_pk_bf16_f32 v99, v94, v95
    buffer_store_dwordx4 v[96:99], v164, s[24:27], s60 offen offset:2048 sc1
    s_lshl_b32 s78, s46, 4
    s_add_u32 s78, s78, s47
    s_lshl_b32 s78, s78, 7
    s_add_u32 s78, s78, 19111936
    s_mov_b32 s36, s18
    s_mov_b32 s37, s19
    s_mov_b32 s38, 2621440
    s_mov_b32 s39, 0x00020000
    s_and_b32 s46, s2, 1
    s_lshl_b32 s46, s46, 4
    s_and_b32 s48, s2, 2
    s_lshl_b32 s48, s48, 2
    s_add_u32 s46, s46, s48
    s_bfe_u32 s48, s2, 0x30003
    s_add_u32 s46, s46, s48
    s_bfe_u32 s47, s2, 0x10002
    s_lshl_b32 s47, s47, 2
    s_lshr_b32 s49, s2, 6
    s_add_u32 s47, s47, s49
    s_mul_i32 s49, s49, 3
    s_lshr_b32 s40, s48, 1
    s_add_u32 s40, s40, s48
    s_add_u32 s40, s40, s49
    s_cmp_ge_u32 s40, 12
    s_cselect_b32 s48, 12, 0
    s_sub_u32 s40, s40, s48
    s_cmp_ge_u32 s40, 9
    s_cselect_b32 s48, 9, 0
    s_sub_u32 s59, s40, s48
    s_mul_i32 s48, s40, 11
    s_lshr_b32 s48, s48, 5
    s_mul_i32 s48, s48, 3
    s_sub_u32 s40, s40, s48
    s_add_u32 s40, s40, 9
    s_mov_b32 s43, s40
    s_mul_i32 s48, s3, 12
    s_mul_i32 s41, s47, 48
    s_add_u32 s41, s41, s48
    s_mul_i32 s41, s41, 5120
    s_add_u32 s41, s41, 0
    s_mul_i32 s42, s46, 48
    s_add_u32 s42, s42, s48
    s_lshl_b32 s42, s42, 12
    s_add_u32 s42, s42, 1966080
    v_add_u32 v88, 4096, v2
    s_lshr_b32 s49, s46, 1
    s_lshl_b32 s49, s49, 11
    s_add_u32 s54, s49, 19111936
    s_add_u32 s49, s49, 19079168
    v_lshlrev_b32 v98, 7, v3
    s_lshl_b32 s52, s46, 6
    s_lshl_b32 s53, s3, 4
    s_add_u32 s52, s52, s53
    s_lshl_b32 s53, s52, 3
    s_add_u32 s53, s53, 18964484
    v_lshlrev_b32 v96, 3, v3
    buffer_load_dword v101, v96, s[24:27], s53 offen sc1
    s_mul_i32 s52, s52, 1280
    s_mul_i32 s53, s47, 160
    s_add_u32 s52, s52, s53
    s_add_u32 s53, s52, 16244736
    v_mul_u32_u24 v97, 1280, v3
    v_lshl_add_u32 v97, v4, 3, v97
    s_add_u32 s50, s3, 0
    s_and_b32 s50, s50, 3
    s_lshl_b32 s51, s50, 10
    v_add_u32 v89, s51, v2
    s_add_u32 s50, s3, 1
    s_and_b32 s50, s50, 3
    s_lshl_b32 s51, s50, 10
    v_add_u32 v90, s51, v2
    s_mul_i32 s51, s50, 15360
    s_add_u32 s51, s51, 0
    v_add_u32 v93, s51, v2
    s_add_u32 s50, s3, 2
    s_and_b32 s50, s50, 3
    s_lshl_b32 s51, s50, 10
    v_add_u32 v91, s51, v2
    s_mul_i32 s51, s50, 15360
    s_add_u32 s51, s51, 5120
    v_add_u32 v94, s51, v2
    s_add_u32 s50, s3, 3
    s_and_b32 s50, s50, 3
    s_lshl_b32 s51, s50, 10
    v_add_u32 v92, s51, v2
    s_mul_i32 s51, s50, 15360
    s_add_u32 s51, s51, 10240
    v_add_u32 v95, s51, v2
    s_waitcnt vmcnt(1)
    s_barrier
    s_cmp_eq_u32 s3, 0
    s_cbranch_scc0 L_pb_14
    v_mov_b32 v96, s88
    s_mov_b64 exec, 1
    buffer_store_dword v96, v5, s[24:27], s78 offen sc0 sc1
    s_mov_b64 exec, -1
    s_nop 0
L_pb_14:
    s_lshl_b32 s48, s3, 9
    s_add_u32 s54, s54, s48
    s_add_u32 s60, s54, 384
    v_and_b32 v96, 3, v1
    v_lshlrev_b32 v96, 7, v96
    buffer_load_dword v252, v5, s[92:95], 0 offen sc1
    buffer_load_dword v102, v5, s[24:27], s60 offen sc1
    s_mul_i32 s44, s40, 5120
    s_add_u32 s44, s44, s41
    s_add_u32 s40, s40, 1
    buffer_load_dwordx4 v[104:107], v2, s[24:27], s44 offen offset:0 sc1
    buffer_load_dwordx4 v[108:111], v2, s[24:27], s44 offen offset:1024 sc1
    s_cmp_eq_u32 s40, 12
    s_cselect_b32 s40, 9, s40
    buffer_load_dwordx4 v[112:115], v2, s[24:27], s44 offen offset:2048 sc1
    buffer_load_dwordx4 v[116:119], v2, s[24:27], s44 offen offset:3072 sc1
    buffer_load_dwordx4 v[120:123], v88, s[24:27], s44 offen offset:0 sc1
    s_mul_i32 s44, s40, 5120
    s_add_u32 s44, s44, s41
    s_add_u32 s40, s40, 1
    buffer_load_dwordx4 v[140:143], v2, s[24:27], s44 offen offset:0 sc1
    buffer_load_dwordx4 v[144:147], v2, s[24:27], s44 offen offset:1024 sc1
    s_cmp_eq_u32 s40, 12
    s_cselect_b32 s40, 9, s40
    buffer_load_dwordx4 v[148:151], v2, s[24:27], s44 offen offset:2048 sc1
    buffer_load_dwordx4 v[152:155], v2, s[24:27], s44 offen offset:3072 sc1
    buffer_load_dwordx4 v[156:159], v88, s[24:27], s44 offen offset:0 sc1
    s_mul_i32 s44, s40, 5120
    s_add_u32 s44, s44, s41
    s_add_u32 s40, s40, 1
    buffer_load_dwordx4 v[176:179], v2, s[24:27], s44 offen offset:0 sc1
    buffer_load_dwordx4 v[180:183], v2, s[24:27], s44 offen offset:1024 sc1
    s_cmp_eq_u32 s40, 12
    s_cselect_b32 s40, 9, s40
    s_sub_u32 s40, s40, 3
    buffer_load_dwordx4 v[184:187], v2, s[24:27], s44 offen offset:2048 sc1
    buffer_load_dwordx4 v[188:191], v2, s[24:27], s44 offen offset:3072 sc1
    buffer_load_dwordx4 v[192:195], v88, s[24:27], s44 offen offset:0 sc1
    s_mul_i32 s44, s40, 5120
    s_add_u32 s44, s44, s41
    s_add_u32 s40, s40, 1
    buffer_load_dwordx4 v[212:215], v2, s[24:27], s44 offen offset:0 sc1
    buffer_load_dwordx4 v[216:219], v2, s[24:27], s44 offen offset:1024 sc1
    s_cmp_eq_u32 s40, 9
    s_cselect_b32 s40, 6, s40
    buffer_load_dwordx4 v[220:223], v2, s[24:27], s44 offen offset:2048 sc1
    buffer_load_dwordx4 v[224:227], v2, s[24:27], s44 offen offset:3072 sc1
    buffer_load_dwordx4 v[228:231], v88, s[24:27], s44 offen offset:0 sc1
    v_mov_b32 v8, 0
    v_mov_b32 v9, 0
    v_mov_b32 v10, 0
    v_mov_b32 v11, 0
    v_mov_b32 v12, 0
    v_mov_b32 v13, 0
    v_mov_b32 v14, 0
    v_mov_b32 v15, 0
    v_mov_b32 v16, 0
    v_mov_b32 v17, 0
    v_mov_b32 v18, 0
    v_mov_b32 v19, 0
    v_mov_b32 v20, 0
    v_mov_b32 v21, 0
    v_mov_b32 v22, 0
    v_mov_b32 v23, 0
    v_mov_b32 v24, 0
    v_mov_b32 v25, 0
    v_mov_b32 v26, 0
    v_mov_b32 v27, 0
    v_mov_b32 v28, 0
    v_mov_b32 v29, 0
    v_mov_b32 v30, 0
    v_mov_b32 v31, 0
    v_mov_b32 v32, 0
    v_mov_b32 v33, 0
    v_mov_b32 v34, 0
    v_mov_b32 v35, 0
    v_mov_b32 v36, 0
    v_mov_b32 v37, 0
    v_mov_b32 v38, 0
    v_mov_b32 v39, 0
    v_mov_b32 v40, 0
    v_mov_b32 v41, 0
    v_mov_b32 v42, 0
    v_mov_b32 v43, 0
    v_mov_b32 v44, 0
    v_mov_b32 v45, 0
    v_mov_b32 v46, 0
    v_mov_b32 v47, 0
    v_mov_b32 v48, 0
    v_mov_b32 v49, 0
    v_mov_b32 v50, 0
    v_mov_b32 v51, 0
    v_mov_b32 v52, 0
    v_mov_b32 v53, 0
    v_mov_b32 v54, 0
    v_mov_b32 v55, 0
    v_mov_b32 v56, 0
    v_mov_b32 v57, 0
    v_mov_b32 v58, 0
    v_mov_b32 v59, 0
    v_mov_b32 v60, 0
    v_mov_b32 v61, 0
    v_mov_b32 v62, 0
    v_mov_b32 v63, 0
    v_mov_b32 v64, 0
    v_mov_b32 v65, 0
    v_mov_b32 v66, 0
    v_mov_b32 v67, 0
    v_mov_b32 v68, 0
    v_mov_b32 v69, 0
    v_mov_b32 v70, 0
    v_mov_b32 v71, 0
    v_mov_b32 v72, 0
    v_mov_b32 v73, 0
    v_mov_b32 v74, 0
    v_mov_b32 v75, 0
    v_mov_b32 v76, 0
    v_mov_b32 v77, 0
    v_mov_b32 v78, 0
    v_mov_b32 v79, 0
    v_mov_b32 v80, 0
    v_mov_b32 v81, 0
    v_mov_b32 v82, 0
    v_mov_b32 v83, 0
    v_mov_b32 v84, 0
    v_mov_b32 v85, 0
    v_mov_b32 v86, 0
    v_mov_b32 v87, 0
    s_waitcnt vmcnt(20)
    s_mov_b32 s89, 0
    s_nop 0
L_eg_15:
    v_readfirstlane_b32 s88, v252
    s_nop 1
    s_cmp_lg_u32 s88, 0
    s_cbranch_scc1 L_ed_16
    s_add_u32 s89, s89, 1
    s_cmp_gt_u32 s89, 20000
    s_cbranch_scc1 L_ed_16
    s_sleep 8
    buffer_load_dword v252, v5, s[92:95], 0 offen sc1
    s_waitcnt vmcnt(0)
    s_branch L_eg_15
    s_nop 0
L_ed_16:
    s_mov_b32 s89, 0
    s_nop 0
L_fw_17:
    v_cmp_ne_u32 vcc, s88, v102
    s_nop 1
    s_cmp_eq_u64 vcc, 0
    s_cbranch_scc1 L_fd_18
    s_add_u32 s89, s89, 1
    s_cmp_gt_u32 s89, 20000
    s_cbranch_scc1 L_fd_18
    s_sleep 2
    buffer_load_dword v102, v5, s[24:27], s60 offen sc1
    s_waitcnt vmcnt(0)
    s_branch L_fw_17
    s_nop 0
L_fd_18:
    buffer_load_dword v102, v96, s[24:27], s54 offen sc1
    s_lshl_b32 s45, s43, 12
    s_add_u32 s45, s45, s42
    s_add_u32 s43, s43, 1
    buffer_load_dwordx4 v[124:127], v89, s[24:27], s45 offen sc1
    buffer_load_dwordx4 v[128:131], v90, s[24:27], s45 offen sc1
    s_cmp_eq_u32 s43, 12
    s_cselect_b32 s43, 9, s43
    buffer_load_dwordx4 v[132:135], v91, s[24:27], s45 offen sc1
    buffer_load_dwordx4 v[136:139], v92, s[24:27], s45 offen sc1
    s_lshl_b32 s45, s43, 12
    s_add_u32 s45, s45, s42
    s_add_u32 s43, s43, 1
    buffer_load_dwordx4 v[160:163], v89, s[24:27], s45 offen sc1
    buffer_load_dwordx4 v[164:167], v90, s[24:27], s45 offen sc1
    s_cmp_eq_u32 s43, 12
    s_cselect_b32 s43, 9, s43
    buffer_load_dwordx4 v[168:171], v91, s[24:27], s45 offen sc1
    buffer_load_dwordx4 v[172:175], v92, s[24:27], s45 offen sc1
    s_lshl_b32 s45, s43, 12
    s_add_u32 s45, s45, s42
    s_add_u32 s43, s43, 1
    buffer_load_dwordx4 v[196:199], v89, s[24:27], s45 offen sc1
    buffer_load_dwordx4 v[200:203], v90, s[24:27], s45 offen sc1
    s_cmp_eq_u32 s43, 12
    s_cselect_b32 s43, 9, s43
    s_sub_u32 s43, s43, 3
    buffer_load_dwordx4 v[204:207], v91, s[24:27], s45 offen sc1
    buffer_load_dwordx4 v[208:211], v92, s[24:27], s45 offen sc1
    s_waitcnt vmcnt(12)
    s_mov_b32 s89, 0
L_ck_19:
    v_cmp_ne_u32 vcc, s88, v102
    s_add_u32 s89, s89, 1
    s_nop 0
    s_bitcmp0_b32 vcc_lo, 2
    s_cbranch_scc1 L_cd_20
    s_cmp_gt_u32 s89, 40000
    s_cbranch_scc1 L_cd_20
    s_sleep 2
    buffer_load_dword v102, v96, s[24:27], s54 offen sc1
    s_waitcnt vmcnt(0)
    s_branch L_ck_19
L_cd_20:
    buffer_load_dword v102, v96, s[24:27], s54 offen sc1
    s_lshl_b32 s45, s43, 12
    s_add_u32 s45, s45, s42
    s_add_u32 s43, s43, 1
    buffer_load_dwordx4 v[232:235], v89, s[24:27], s45 offen sc1
    buffer_load_dwordx4 v[236:239], v90, s[24:27], s45 offen sc1
    s_cmp_eq_u32 s43, 9
    s_cselect_b32 s43, 6, s43
    buffer_load_dwordx4 v[240:243], v91, s[24:27], s45 offen sc1
    buffer_load_dwordx4 v[244:247], v92, s[24:27], s45 offen sc1
    s_waitcnt vmcnt(12)
    v_mfma_f32_16x16x32_bf16 v[8:11], v[104:107], v[124:127], v[8:11]
    v_mfma_f32_16x16x32_bf16 v[28:31], v[104:107], v[128:131], v[28:31]
    v_mfma_f32_16x16x32_bf16 v[48:51], v[104:107], v[132:135], v[48:51]
    v_mfma_f32_16x16x32_bf16 v[68:71], v[104:107], v[136:139], v[68:71]
    s_mul_i32 s44, s40, 5120
    s_add_u32 s44, s44, s41
    s_add_u32 s40, s40, 1
    buffer_load_dwordx4 v[104:107], v2, s[24:27], s44 offen offset:0 sc1
    v_mfma_f32_16x16x32_bf16 v[12:15], v[108:111], v[124:127], v[12:15]
    v_mfma_f32_16x16x32_bf16 v[32:35], v[108:111], v[128:131], v[32:35]
    v_mfma_f32_16x16x32_bf16 v[52:55], v[108:111], v[132:135], v[52:55]
    v_mfma_f32_16x16x32_bf16 v[72:75], v[108:111], v[136:139], v[72:75]
    buffer_load_dwordx4 v[108:111], v2, s[24:27], s44 offen offset:1024 sc1
    s_cmp_eq_u32 s40, 9
    s_cselect_b32 s40, 6, s40
    v_mfma_f32_16x16x32_bf16 v[16:19], v[112:115], v[124:127], v[16:19]
    v_mfma_f32_16x16x32_bf16 v[36:39], v[112:115], v[128:131], v[36:39]
    v_mfma_f32_16x16x32_bf16 v[56:59], v[112:115], v[132:135], v[56:59]
    v_mfma_f32_16x16x32_bf16 v[76:79], v[112:115], v[136:139], v[76:79]
    buffer_load_dwordx4 v[112:115], v2, s[24:27], s44 offen offset:2048 sc1
    v_mfma_f32_16x16x32_bf16 v[20:23], v[116:119], v[124:127], v[20:23]
    v_mfma_f32_16x16x32_bf16 v[40:43], v[116:119], v[128:131], v[40:43]
    v_mfma_f32_16x16x32_bf16 v[60:63], v[116:119], v[132:135], v[60:63]
    v_mfma_f32_16x16x32_bf16 v[80:83], v[116:119], v[136:139], v[80:83]
    buffer_load_dwordx4 v[116:119], v2, s[24:27], s44 offen offset:3072 sc1
    v_mfma_f32_16x16x32_bf16 v[24:27], v[120:123], v[124:127], v[24:27]
    v_mfma_f32_16x16x32_bf16 v[44:47], v[120:123], v[128:131], v[44:47]
    v_mfma_f32_16x16x32_bf16 v[64:67], v[120:123], v[132:135], v[64:67]
    v_mfma_f32_16x16x32_bf16 v[84:87], v[120:123], v[136:139], v[84:87]
    buffer_load_dwordx4 v[120:123], v88, s[24:27], s44 offen offset:0 sc1
    s_lshl_b32 s45, s43, 12
    s_add_u32 s45, s45, s42
    s_add_u32 s43, s43, 1
    buffer_load_dwordx4 v[124:127], v89, s[24:27], s45 offen sc1
    buffer_load_dwordx4 v[128:131], v90, s[24:27], s45 offen sc1
    s_cmp_eq_u32 s43, 9
    s_cselect_b32 s43, 6, s43
    buffer_load_dwordx4 v[132:135], v91, s[24:27], s45 offen sc1
    buffer_load_dwordx4 v[136:139], v92, s[24:27], s45 offen sc1
    s_waitcnt vmcnt(17)
    v_mfma_f32_16x16x32_bf16 v[8:11], v[140:143], v[160:163], v[8:11]
    v_mfma_f32_16x16x32_bf16 v[28:31], v[140:143], v[164:167], v[28:31]
    v_mfma_f32_16x16x32_bf16 v[48:51], v[140:143], v[168:171], v[48:51]
    v_mfma_f32_16x16x32_bf16 v[68:71], v[140:143], v[172:175], v[68:71]
    s_mul_i32 s44, s40, 5120
    s_add_u32 s44, s44, s41
    s_add_u32 s40, s40, 1
    buffer_load_dwordx4 v[140:143], v2, s[24:27], s44 offen offset:0 sc1
    v_mfma_f32_16x16x32_bf16 v[12:15], v[144:147], v[160:163], v[12:15]
    v_mfma_f32_16x16x32_bf16 v[32:35], v[144:147], v[164:167], v[32:35]
    v_mfma_f32_16x16x32_bf16 v[52:55], v[144:147], v[168:171], v[52:55]
    v_mfma_f32_16x16x32_bf16 v[72:75], v[144:147], v[172:175], v[72:75]
    buffer_load_dwordx4 v[144:147], v2, s[24:27], s44 offen offset:1024 sc1
    s_cmp_eq_u32 s40, 9
    s_cselect_b32 s40, 6, s40
    s_sub_u32 s40, s40, 3
    v_mfma_f32_16x16x32_bf16 v[16:19], v[148:151], v[160:163], v[16:19]
    v_mfma_f32_16x16x32_bf16 v[36:39], v[148:151], v[164:167], v[36:39]
    v_mfma_f32_16x16x32_bf16 v[56:59], v[148:151], v[168:171], v[56:59]
    v_mfma_f32_16x16x32_bf16 v[76:79], v[148:151], v[172:175], v[76:79]
    buffer_load_dwordx4 v[148:151], v2, s[24:27], s44 offen offset:2048 sc1
    v_mfma_f32_16x16x32_bf16 v[20:23], v[152:155], v[160:163], v[20:23]
    v_mfma_f32_16x16x32_bf16 v[40:43], v[152:155], v[164:167], v[40:43]
    v_mfma_f32_16x16x32_bf16 v[60:63], v[152:155], v[168:171], v[60:63]
    v_mfma_f32_16x16x32_bf16 v[80:83], v[152:155], v[172:175], v[80:83]
    buffer_load_dwordx4 v[152:155], v2, s[24:27], s44 offen offset:3072 sc1
    v_mfma_f32_16x16x32_bf16 v[24:27], v[156:159], v[160:163], v[24:27]
    v_mfma_f32_16x16x32_bf16 v[44:47], v[156:159], v[164:167], v[44:47]
    v_mfma_f32_16x16x32_bf16 v[64:67], v[156:159], v[168:171], v[64:67]
    v_mfma_f32_16x16x32_bf16 v[84:87], v[156:159], v[172:175], v[84:87]
    buffer_load_dwordx4 v[156:159], v88, s[24:27], s44 offen offset:0 sc1
    s_lshl_b32 s45, s43, 12
    s_add_u32 s45, s45, s42
    s_add_u32 s43, s43, 1
    buffer_load_dwordx4 v[160:163], v89, s[24:27], s45 offen sc1
    buffer_load_dwordx4 v[164:167], v90, s[24:27], s45 offen sc1
    s_cmp_eq_u32 s43, 9
    s_cselect_b32 s43, 6, s43
    s_sub_u32 s43, s43, 3
    buffer_load_dwordx4 v[168:171], v91, s[24:27], s45 offen sc1
    buffer_load_dwordx4 v[172:175], v92, s[24:27], s45 offen sc1
    s_waitcnt vmcnt(22)
    v_mfma_f32_16x16x32_bf16 v[8:11], v[176:179], v[196:199], v[8:11]
    v_mfma_f32_16x16x32_bf16 v[28:31], v[176:179], v[200:203], v[28:31]
    v_mfma_f32_16x16x32_bf16 v[48:51], v[176:179], v[204:207], v[48:51]
    v_mfma_f32_16x16x32_bf16 v[68:71], v[176:179], v[208:211], v[68:71]
    s_mul_i32 s44, s40, 5120
    s_add_u32 s44, s44, s41
    s_add_u32 s40, s40, 1
    buffer_load_dwordx4 v[176:179], v2, s[24:27], s44 offen offset:0 sc1
    v_mfma_f32_16x16x32_bf16 v[12:15], v[180:183], v[196:199], v[12:15]
    v_mfma_f32_16x16x32_bf16 v[32:35], v[180:183], v[200:203], v[32:35]
    v_mfma_f32_16x16x32_bf16 v[52:55], v[180:183], v[204:207], v[52:55]
    v_mfma_f32_16x16x32_bf16 v[72:75], v[180:183], v[208:211], v[72:75]
    buffer_load_dwordx4 v[180:183], v2, s[24:27], s44 offen offset:1024 sc1
    s_cmp_eq_u32 s40, 6
    s_cselect_b32 s40, 3, s40
    v_mfma_f32_16x16x32_bf16 v[16:19], v[184:187], v[196:199], v[16:19]
    v_mfma_f32_16x16x32_bf16 v[36:39], v[184:187], v[200:203], v[36:39]
    v_mfma_f32_16x16x32_bf16 v[56:59], v[184:187], v[204:207], v[56:59]
    v_mfma_f32_16x16x32_bf16 v[76:79], v[184:187], v[208:211], v[76:79]
    buffer_load_dwordx4 v[184:187], v2, s[24:27], s44 offen offset:2048 sc1
    v_mfma_f32_16x16x32_bf16 v[20:23], v[188:191], v[196:199], v[20:23]
    v_mfma_f32_16x16x32_bf16 v[40:43], v[188:191], v[200:203], v[40:43]
    v_mfma_f32_16x16x32_bf16 v[60:63], v[188:191], v[204:207], v[60:63]
    v_mfma_f32_16x16x32_bf16 v[80:83], v[188:191], v[208:211], v[80:83]
    buffer_load_dwordx4 v[188:191], v2, s[24:27], s44 offen offset:3072 sc1
    v_mfma_f32_16x16x32_bf16 v[24:27], v[192:195], v[196:199], v[24:27]
    v_mfma_f32_16x16x32_bf16 v[44:47], v[192:195], v[200:203], v[44:47]
    v_mfma_f32_16x16x32_bf16 v[64:67], v[192:195], v[204:207], v[64:67]
    v_mfma_f32_16x16x32_bf16 v[84:87], v[192:195], v[208:211], v[84:87]
    buffer_load_dwordx4 v[192:195], v88, s[24:27], s44 offen offset:0 sc1
    s_waitcnt vmcnt(27)
    s_mov_b32 s89, 0
L_ck_21:
    v_cmp_ne_u32 vcc, s88, v102
    s_add_u32 s89, s89, 1
    s_nop 0
    s_bitcmp0_b32 vcc_lo, 1
    s_cbranch_scc1 L_cd_22
    s_cmp_gt_u32 s89, 40000
    s_cbranch_scc1 L_cd_22
    s_sleep 2
    buffer_load_dword v102, v96, s[24:27], s54 offen sc1
    s_waitcnt vmcnt(0)
    s_branch L_ck_21
L_cd_22:
    buffer_load_dword v102, v96, s[24:27], s54 offen sc1
    s_lshl_b32 s45, s43, 12
    s_add_u32 s45, s45, s42
    s_add_u32 s43, s43, 1
    buffer_load_dwordx4 v[196:199], v89, s[24:27], s45 offen sc1
    buffer_load_dwordx4 v[200:203], v90, s[24:27], s45 offen sc1
    s_cmp_eq_u32 s43, 6
    s_cselect_b32 s43, 3, s43
    buffer_load_dwordx4 v[204:207], v91, s[24:27], s45 offen sc1
    buffer_load_dwordx4 v[208:211], v92, s[24:27], s45 offen sc1
    s_waitcnt vmcnt(27)
    v_mfma_f32_16x16x32_bf16 v[8:11], v[212:215], v[232:235], v[8:11]
    v_mfma_f32_16x16x32_bf16 v[28:31], v[212:215], v[236:239], v[28:31]
    v_mfma_f32_16x16x32_bf16 v[48:51], v[212:215], v[240:243], v[48:51]
    v_mfma_f32_16x16x32_bf16 v[68:71], v[212:215], v[244:247], v[68:71]
    s_mul_i32 s44, s40, 5120
    s_add_u32 s44, s44, s41
    s_add_u32 s40, s40, 1
    buffer_load_dwordx4 v[212:215], v2, s[24:27], s44 offen offset:0 sc1
    v_mfma_f32_16x16x32_bf16 v[12:15], v[216:219], v[232:235], v[12:15]
    v_mfma_f32_16x16x32_bf16 v[32:35], v[216:219], v[236:239], v[32:35]
    v_mfma_f32_16x16x32_bf16 v[52:55], v[216:219], v[240:243], v[52:55]
    v_mfma_f32_16x16x32_bf16 v[72:75], v[216:219], v[244:247], v[72:75]
    buffer_load_dwordx4 v[216:219], v2, s[24:27], s44 offen offset:1024 sc1
    s_cmp_eq_u32 s40, 6
    s_cselect_b32 s40, 3, s40
    v_mfma_f32_16x16x32_bf16 v[16:19], v[220:223], v[232:235], v[16:19]
    v_mfma_f32_16x16x32_bf16 v[36:39], v[220:223], v[236:239], v[36:39]
    v_mfma_f32_16x16x32_bf16 v[56:59], v[220:223], v[240:243], v[56:59]
    v_mfma_f32_16x16x32_bf16 v[76:79], v[220:223], v[244:247], v[76:79]
    buffer_load_dwordx4 v[220:223], v2, s[24:27], s44 offen offset:2048 sc1
    v_mfma_f32_16x16x32_bf16 v[20:23], v[224:227], v[232:235], v[20:23]
    v_mfma_f32_16x16x32_bf16 v[40:43], v[224:227], v[236:239], v[40:43]
    v_mfma_f32_16x16x32_bf16 v[60:63], v[224:227], v[240:243], v[60:63]
    v_mfma_f32_16x16x32_bf16 v[80:83], v[224:227], v[244:247], v[80:83]
    buffer_load_dwordx4 v[224:227], v2, s[24:27], s44 offen offset:3072 sc1
    v_mfma_f32_16x16x32_bf16 v[24:27], v[228:231], v[232:235], v[24:27]
    v_mfma_f32_16x16x32_bf16 v[44:47], v[228:231], v[236:239], v[44:47]
    v_mfma_f32_16x16x32_bf16 v[64:67], v[228:231], v[240:243], v[64:67]
    v_mfma_f32_16x16x32_bf16 v[84:87], v[228:231], v[244:247], v[84:87]
    buffer_load_dwordx4 v[228:231], v88, s[24:27], s44 offen offset:0 sc1
    s_lshl_b32 s45, s43, 12
    s_add_u32 s45, s45, s42
    s_add_u32 s43, s43, 1
    buffer_load_dwordx4 v[232:235], v89, s[24:27], s45 offen sc1
    buffer_load_dwordx4 v[236:239], v90, s[24:27], s45 offen sc1
    s_cmp_eq_u32 s43, 6
    s_cselect_b32 s43, 3, s43
    buffer_load_dwordx4 v[240:243], v91, s[24:27], s45 offen sc1
    buffer_load_dwordx4 v[244:247], v92, s[24:27], s45 offen sc1
    s_waitcnt vmcnt(27)
    v_mfma_f32_16x16x32_bf16 v[8:11], v[104:107], v[124:127], v[8:11]
    v_mfma_f32_16x16x32_bf16 v[28:31], v[104:107], v[128:131], v[28:31]
    v_mfma_f32_16x16x32_bf16 v[48:51], v[104:107], v[132:135], v[48:51]
    v_mfma_f32_16x16x32_bf16 v[68:71], v[104:107], v[136:139], v[68:71]
    s_mul_i32 s44, s40, 5120
    s_add_u32 s44, s44, s41
    s_add_u32 s40, s40, 1
    buffer_load_dwordx4 v[104:107], v2, s[24:27], s44 offen offset:0 sc1
    v_mfma_f32_16x16x32_bf16 v[12:15], v[108:111], v[124:127], v[12:15]
    v_mfma_f32_16x16x32_bf16 v[32:35], v[108:111], v[128:131], v[32:35]
    v_mfma_f32_16x16x32_bf16 v[52:55], v[108:111], v[132:135], v[52:55]
    v_mfma_f32_16x16x32_bf16 v[72:75], v[108:111], v[136:139], v[72:75]
    buffer_load_dwordx4 v[108:111], v2, s[24:27], s44 offen offset:1024 sc1
    s_cmp_eq_u32 s40, 6
    s_cselect_b32 s40, 3, s40
    s_sub_u32 s40, s40, 3
    v_mfma_f32_16x16x32_bf16 v[16:19], v[112:115], v[124:127], v[16:19]
    v_mfma_f32_16x16x32_bf16 v[36:39], v[112:115], v[128:131], v[36:39]
    v_mfma_f32_16x16x32_bf16 v[56:59], v[112:115], v[132:135], v[56:59]
    v_mfma_f32_16x16x32_bf16 v[76:79], v[112:115], v[136:139], v[76:79]
    buffer_load_dwordx4 v[112:115], v2, s[24:27], s44 offen offset:2048 sc1
    v_mfma_f32_16x16x32_bf16 v[20:23], v[116:119], v[124:127], v[20:23]
    v_mfma_f32_16x16x32_bf16 v[40:43], v[116:119], v[128:131], v[40:43]
    v_mfma_f32_16x16x32_bf16 v[60:63], v[116:119], v[132:135], v[60:63]
    v_mfma_f32_16x16x32_bf16 v[80:83], v[116:119], v[136:139], v[80:83]
    buffer_load_dwordx4 v[116:119], v2, s[24:27], s44 offen offset:3072 sc1
    v_mfma_f32_16x16x32_bf16 v[24:27], v[120:123], v[124:127], v[24:27]
    v_mfma_f32_16x16x32_bf16 v[44:47], v[120:123], v[128:131], v[44:47]
    v_mfma_f32_16x16x32_bf16 v[64:67], v[120:123], v[132:135], v[64:67]
    v_mfma_f32_16x16x32_bf16 v[84:87], v[120:123], v[136:139], v[84:87]
    buffer_load_dwordx4 v[120:123], v88, s[24:27], s44 offen offset:0 sc1
    s_lshl_b32 s45, s43, 12
    s_add_u32 s45, s45, s42
    s_add_u32 s43, s43, 1
    buffer_load_dwordx4 v[124:127], v89, s[24:27], s45 offen sc1
    buffer_load_dwordx4 v[128:131], v90, s[24:27], s45 offen sc1
    s_cmp_eq_u32 s43, 6
    s_cselect_b32 s43, 3, s43
    s_sub_u32 s43, s43, 3
    buffer_load_dwordx4 v[132:135], v91, s[24:27], s45 offen sc1
    buffer_load_dwordx4 v[136:139], v92, s[24:27], s45 offen sc1
    s_waitcnt vmcnt(27)
    v_mfma_f32_16x16x32_bf16 v[8:11], v[140:143], v[160:163], v[8:11]
    v_mfma_f32_16x16x32_bf16 v[28:31], v[140:143], v[164:167], v[28:31]
    v_mfma_f32_16x16x32_bf16 v[48:51], v[140:143], v[168:171], v[48:51]
    v_mfma_f32_16x16x32_bf16 v[68:71], v[140:143], v[172:175], v[68:71]
    s_mul_i32 s44, s40, 5120
    s_add_u32 s44, s44, s41
    s_add_u32 s40, s40, 1
    buffer_load_dwordx4 v[140:143], v2, s[24:27], s44 offen offset:0 sc1
    v_mfma_f32_16x16x32_bf16 v[12:15], v[144:147], v[160:163], v[12:15]
    v_mfma_f32_16x16x32_bf16 v[32:35], v[144:147], v[164:167], v[32:35]
    v_mfma_f32_16x16x32_bf16 v[52:55], v[144:147], v[168:171], v[52:55]
    v_mfma_f32_16x16x32_bf16 v[72:75], v[144:147], v[172:175], v[72:75]
    buffer_load_dwordx4 v[144:147], v2, s[24:27], s44 offen offset:1024 sc1
    s_cmp_eq_u32 s40, 3
    s_cselect_b32 s40, 0, s40
    v_mfma_f32_16x16x32_bf16 v[16:19], v[148:151], v[160:163], v[16:19]
    v_mfma_f32_16x16x32_bf16 v[36:39], v[148:151], v[164:167], v[36:39]
    v_mfma_f32_16x16x32_bf16 v[56:59], v[148:151], v[168:171], v[56:59]
    v_mfma_f32_16x16x32_bf16 v[76:79], v[148:151], v[172:175], v[76:79]
    buffer_load_dwordx4 v[148:151], v2, s[24:27], s44 offen offset:2048 sc1
    v_mfma_f32_16x16x32_bf16 v[20:23], v[152:155], v[160:163], v[20:23]
    v_mfma_f32_16x16x32_bf16 v[40:43], v[152:155], v[164:167], v[40:43]
    v_mfma_f32_16x16x32_bf16 v[60:63], v[152:155], v[168:171], v[60:63]
    v_mfma_f32_16x16x32_bf16 v[80:83], v[152:155], v[172:175], v[80:83]
    buffer_load_dwordx4 v[152:155], v2, s[24:27], s44 offen offset:3072 sc1
    v_mfma_f32_16x16x32_bf16 v[24:27], v[156:159], v[160:163], v[24:27]
    v_mfma_f32_16x16x32_bf16 v[44:47], v[156:159], v[164:167], v[44:47]
    v_mfma_f32_16x16x32_bf16 v[64:67], v[156:159], v[168:171], v[64:67]
    v_mfma_f32_16x16x32_bf16 v[84:87], v[156:159], v[172:175], v[84:87]
    buffer_load_dwordx4 v[156:159], v88, s[24:27], s44 offen offset:0 sc1
    s_waitcnt vmcnt(27)
    s_mov_b32 s89, 0
L_ck_23:
    v_cmp_ne_u32 vcc, s88, v102
    s_add_u32 s89, s89, 1
    s_nop 0
    s_bitcmp0_b32 vcc_lo, 0
    s_cbranch_scc1 L_cd_24
    s_cmp_gt_u32 s89, 40000
    s_cbranch_scc1 L_cd_24
    s_sleep 2
    buffer_load_dword v102, v96, s[24:27], s54 offen sc1
    s_waitcnt vmcnt(0)
    s_branch L_ck_23
L_cd_24:
    s_lshl_b32 s45, s43, 12
    s_add_u32 s45, s45, s42
    s_add_u32 s43, s43, 1
    buffer_load_dwordx4 v[160:163], v89, s[24:27], s45 offen sc1
    buffer_load_dwordx4 v[164:167], v90, s[24:27], s45 offen sc1
    s_cmp_eq_u32 s43, 3
    s_cselect_b32 s43, 0, s43
    buffer_load_dwordx4 v[168:171], v91, s[24:27], s45 offen sc1
    buffer_load_dwordx4 v[172:175], v92, s[24:27], s45 offen sc1
    s_waitcnt vmcnt(27)
    v_mfma_f32_16x16x32_bf16 v[8:11], v[176:179], v[196:199], v[8:11]
    v_mfma_f32_16x16x32_bf16 v[28:31], v[176:179], v[200:203], v[28:31]
    v_mfma_f32_16x16x32_bf16 v[48:51], v[176:179], v[204:207], v[48:51]
    v_mfma_f32_16x16x32_bf16 v[68:71], v[176:179], v[208:211], v[68:71]
    s_mul_i32 s44, s40, 5120
    s_add_u32 s44, s44, s41
    s_add_u32 s40, s40, 1
    buffer_load_dwordx4 v[176:179], v2, s[24:27], s44 offen offset:0 sc1
    v_mfma_f32_16x16x32_bf16 v[12:15], v[180:183], v[196:199], v[12:15]
    v_mfma_f32_16x16x32_bf16 v[32:35], v[180:183], v[200:203], v[32:35]
    v_mfma_f32_16x16x32_bf16 v[52:55], v[180:183], v[204:207], v[52:55]
    v_mfma_f32_16x16x32_bf16 v[72:75], v[180:183], v[208:211], v[72:75]
    buffer_load_dwordx4 v[180:183], v2, s[24:27], s44 offen offset:1024 sc1
    s_cmp_eq_u32 s40, 3
    s_cselect_b32 s40, 0, s40
    v_mfma_f32_16x16x32_bf16 v[16:19], v[184:187], v[196:199], v[16:19]
    v_mfma_f32_16x16x32_bf16 v[36:39], v[184:187], v[200:203], v[36:39]
    v_mfma_f32_16x16x32_bf16 v[56:59], v[184:187], v[204:207], v[56:59]
    v_mfma_f32_16x16x32_bf16 v[76:79], v[184:187], v[208:211], v[76:79]
    buffer_load_dwordx4 v[184:187], v2, s[24:27], s44 offen offset:2048 sc1
    v_mfma_f32_16x16x32_bf16 v[20:23], v[188:191], v[196:199], v[20:23]
    v_mfma_f32_16x16x32_bf16 v[40:43], v[188:191], v[200:203], v[40:43]
    v_mfma_f32_16x16x32_bf16 v[60:63], v[188:191], v[204:207], v[60:63]
    v_mfma_f32_16x16x32_bf16 v[80:83], v[188:191], v[208:211], v[80:83]
    buffer_load_dwordx4 v[188:191], v2, s[24:27], s44 offen offset:3072 sc1
    v_mfma_f32_16x16x32_bf16 v[24:27], v[192:195], v[196:199], v[24:27]
    v_mfma_f32_16x16x32_bf16 v[44:47], v[192:195], v[200:203], v[44:47]
    v_mfma_f32_16x16x32_bf16 v[64:67], v[192:195], v[204:207], v[64:67]
    v_mfma_f32_16x16x32_bf16 v[84:87], v[192:195], v[208:211], v[84:87]
    buffer_load_dwordx4 v[192:195], v88, s[24:27], s44 offen offset:0 sc1
    s_lshl_b32 s45, s43, 12
    s_add_u32 s45, s45, s42
    s_add_u32 s43, s43, 1
    buffer_load_dwordx4 v[196:199], v89, s[24:27], s45 offen sc1
    buffer_load_dwordx4 v[200:203], v90, s[24:27], s45 offen sc1
    s_cmp_eq_u32 s43, 3
    s_cselect_b32 s43, 0, s43
    buffer_load_dwordx4 v[204:207], v91, s[24:27], s45 offen sc1
    buffer_load_dwordx4 v[208:211], v92, s[24:27], s45 offen sc1
    s_waitcnt vmcnt(27)
    v_mfma_f32_16x16x32_bf16 v[8:11], v[212:215], v[232:235], v[8:11]
    v_mfma_f32_16x16x32_bf16 v[28:31], v[212:215], v[236:239], v[28:31]
    v_mfma_f32_16x16x32_bf16 v[48:51], v[212:215], v[240:243], v[48:51]
    v_mfma_f32_16x16x32_bf16 v[68:71], v[212:215], v[244:247], v[68:71]
    s_mul_i32 s44, s40, 5120
    s_add_u32 s44, s44, s41
    s_add_u32 s40, s40, 1
    buffer_load_dwordx4 v[212:215], v2, s[24:27], s44 offen offset:0 sc1
    v_mfma_f32_16x16x32_bf16 v[12:15], v[216:219], v[232:235], v[12:15]
    v_mfma_f32_16x16x32_bf16 v[32:35], v[216:219], v[236:239], v[32:35]
    v_mfma_f32_16x16x32_bf16 v[52:55], v[216:219], v[240:243], v[52:55]
    v_mfma_f32_16x16x32_bf16 v[72:75], v[216:219], v[244:247], v[72:75]
    buffer_load_dwordx4 v[216:219], v2, s[24:27], s44 offen offset:1024 sc1
    s_cmp_eq_u32 s40, 3
    s_cselect_b32 s40, 0, s40
    s_sub_u32 s40, s40, 3
    v_mfma_f32_16x16x32_bf16 v[16:19], v[220:223], v[232:235], v[16:19]
    v_mfma_f32_16x16x32_bf16 v[36:39], v[220:223], v[236:239], v[36:39]
    v_mfma_f32_16x16x32_bf16 v[56:59], v[220:223], v[240:243], v[56:59]
    v_mfma_f32_16x16x32_bf16 v[76:79], v[220:223], v[244:247], v[76:79]
    buffer_load_dwordx4 v[220:223], v2, s[24:27], s44 offen offset:2048 sc1
    v_mfma_f32_16x16x32_bf16 v[20:23], v[224:227], v[232:235], v[20:23]
    v_mfma_f32_16x16x32_bf16 v[40:43], v[224:227], v[236:239], v[40:43]
    v_mfma_f32_16x16x32_bf16 v[60:63], v[224:227], v[240:243], v[60:63]
    v_mfma_f32_16x16x32_bf16 v[80:83], v[224:227], v[244:247], v[80:83]
    buffer_load_dwordx4 v[224:227], v2, s[24:27], s44 offen offset:3072 sc1
    v_mfma_f32_16x16x32_bf16 v[24:27], v[228:231], v[232:235], v[24:27]
    v_mfma_f32_16x16x32_bf16 v[44:47], v[228:231], v[236:239], v[44:47]
    v_mfma_f32_16x16x32_bf16 v[64:67], v[228:231], v[240:243], v[64:67]
    v_mfma_f32_16x16x32_bf16 v[84:87], v[228:231], v[244:247], v[84:87]
    buffer_load_dwordx4 v[228:231], v88, s[24:27], s44 offen offset:0 sc1
    s_lshl_b32 s45, s43, 12
    s_add_u32 s45, s45, s42
    s_add_u32 s43, s43, 1
    buffer_load_dwordx4 v[232:235], v89, s[24:27], s45 offen sc1
    buffer_load_dwordx4 v[236:239], v90, s[24:27], s45 offen sc1
    s_cmp_eq_u32 s43, 3
    s_cselect_b32 s43, 0, s43
    s_sub_u32 s43, s43, 3
    buffer_load_dwordx4 v[240:243], v91, s[24:27], s45 offen sc1
    buffer_load_dwordx4 v[244:247], v92, s[24:27], s45 offen sc1
    s_cmp_eq_u32 s3, 0
    s_cselect_b32 s50, s49, 1073741824
    buffer_load_dword v102, v98, s[24:27], s50 offen sc1
    s_waitcnt vmcnt(28)
    v_mfma_f32_16x16x32_bf16 v[8:11], v[104:107], v[124:127], v[8:11]
    v_mfma_f32_16x16x32_bf16 v[28:31], v[104:107], v[128:131], v[28:31]
    v_mfma_f32_16x16x32_bf16 v[48:51], v[104:107], v[132:135], v[48:51]
    v_mfma_f32_16x16x32_bf16 v[68:71], v[104:107], v[136:139], v[68:71]
    v_mfma_f32_16x16x32_bf16 v[12:15], v[108:111], v[124:127], v[12:15]
    v_mfma_f32_16x16x32_bf16 v[32:35], v[108:111], v[128:131], v[32:35]
    v_mfma_f32_16x16x32_bf16 v[52:55], v[108:111], v[132:135], v[52:55]
    v_mfma_f32_16x16x32_bf16 v[72:75], v[108:111], v[136:139], v[72:75]
    v_mfma_f32_16x16x32_bf16 v[16:19], v[112:115], v[124:127], v[16:19]
    v_mfma_f32_16x16x32_bf16 v[36:39], v[112:115], v[128:131], v[36:39]
    v_mfma_f32_16x16x32_bf16 v[56:59], v[112:115], v[132:135], v[56:59]
    v_mfma_f32_16x16x32_bf16 v[76:79], v[112:115], v[136:139], v[76:79]
    v_mfma_f32_16x16x32_bf16 v[20:23], v[116:119], v[124:127], v[20:23]
    v_mfma_f32_16x16x32_bf16 v[40:43], v[116:119], v[128:131], v[40:43]
    v_mfma_f32_16x16x32_bf16 v[60:63], v[116:119], v[132:135], v[60:63]
    v_mfma_f32_16x16x32_bf16 v[80:83], v[116:119], v[136:139], v[80:83]
    v_mfma_f32_16x16x32_bf16 v[24:27], v[120:123], v[124:127], v[24:27]
    v_mfma_f32_16x16x32_bf16 v[44:47], v[120:123], v[128:131], v[44:47]
    v_mfma_f32_16x16x32_bf16 v[64:67], v[120:123], v[132:135], v[64:67]
    v_mfma_f32_16x16x32_bf16 v[84:87], v[120:123], v[136:139], v[84:87]
    s_waitcnt vmcnt(19)
    v_mfma_f32_16x16x32_bf16 v[8:11], v[140:143], v[160:163], v[8:11]
    v_mfma_f32_16x16x32_bf16 v[28:31], v[140:143], v[164:167], v[28:31]
    v_mfma_f32_16x16x32_bf16 v[48:51], v[140:143], v[168:171], v[48:51]
    v_mfma_f32_16x16x32_bf16 v[68:71], v[140:143], v[172:175], v[68:71]
    v_mfma_f32_16x16x32_bf16 v[12:15], v[144:147], v[160:163], v[12:15]
    v_mfma_f32_16x16x32_bf16 v[32:35], v[144:147], v[164:167], v[32:35]
    v_mfma_f32_16x16x32_bf16 v[52:55], v[144:147], v[168:171], v[52:55]
    v_mfma_f32_16x16x32_bf16 v[72:75], v[144:147], v[172:175], v[72:75]
    v_mfma_f32_16x16x32_bf16 v[16:19], v[148:151], v[160:163], v[16:19]
    v_mfma_f32_16x16x32_bf16 v[36:39], v[148:151], v[164:167], v[36:39]
    v_mfma_f32_16x16x32_bf16 v[56:59], v[148:151], v[168:171], v[56:59]
    v_mfma_f32_16x16x32_bf16 v[76:79], v[148:151], v[172:175], v[76:79]
    v_mfma_f32_16x16x32_bf16 v[20:23], v[152:155], v[160:163], v[20:23]
    v_mfma_f32_16x16x32_bf16 v[40:43], v[152:155], v[164:167], v[40:43]
    v_mfma_f32_16x16x32_bf16 v[60:63], v[152:155], v[168:171], v[60:63]
    v_mfma_f32_16x16x32_bf16 v[80:83], v[152:155], v[172:175], v[80:83]
    v_mfma_f32_16x16x32_bf16 v[24:27], v[156:159], v[160:163], v[24:27]
    v_mfma_f32_16x16x32_bf16 v[44:47], v[156:159], v[164:167], v[44:47]
    v_mfma_f32_16x16x32_bf16 v[64:67], v[156:159], v[168:171], v[64:67]
    v_mfma_f32_16x16x32_bf16 v[84:87], v[156:159], v[172:175], v[84:87]
    s_waitcnt vmcnt(10)
    v_mfma_f32_16x16x32_bf16 v[8:11], v[176:179], v[196:199], v[8:11]
    v_mfma_f32_16x16x32_bf16 v[28:31], v[176:179], v[200:203], v[28:31]
    v_mfma_f32_16x16x32_bf16 v[48:51], v[176:179], v[204:207], v[48:51]
    v_mfma_f32_16x16x32_bf16 v[68:71], v[176:179], v[208:211], v[68:71]
    v_mfma_f32_16x16x32_bf16 v[12:15], v[180:183], v[196:199], v[12:15]
    v_mfma_f32_16x16x32_bf16 v[32:35], v[180:183], v[200:203], v[32:35]
    v_mfma_f32_16x16x32_bf16 v[52:55], v[180:183], v[204:207], v[52:55]
    v_mfma_f32_16x16x32_bf16 v[72:75], v[180:183], v[208:211], v[72:75]
    v_mfma_f32_16x16x32_bf16 v[16:19], v[184:187], v[196:199], v[16:19]
    v_mfma_f32_16x16x32_bf16 v[36:39], v[184:187], v[200:203], v[36:39]
    v_mfma_f32_16x16x32_bf16 v[56:59], v[184:187], v[204:207], v[56:59]
    v_mfma_f32_16x16x32_bf16 v[76:79], v[184:187], v[208:211], v[76:79]
    v_mfma_f32_16x16x32_bf16 v[20:23], v[188:191], v[196:199], v[20:23]
    v_mfma_f32_16x16x32_bf16 v[40:43], v[188:191], v[200:203], v[40:43]
    v_mfma_f32_16x16x32_bf16 v[60:63], v[188:191], v[204:207], v[60:63]
    v_mfma_f32_16x16x32_bf16 v[80:83], v[188:191], v[208:211], v[80:83]
    v_mfma_f32_16x16x32_bf16 v[24:27], v[192:195], v[196:199], v[24:27]
    v_mfma_f32_16x16x32_bf16 v[44:47], v[192:195], v[200:203], v[44:47]
    v_mfma_f32_16x16x32_bf16 v[64:67], v[192:195], v[204:207], v[64:67]
    v_mfma_f32_16x16x32_bf16 v[84:87], v[192:195], v[208:211], v[84:87]
    s_waitcnt vmcnt(0)
    s_cmp_eq_u32 s3, 0
    s_cbranch_scc0 L_dp_25
    s_mov_b32 s89, 0
    s_nop 3
L_fw_26:
    v_cmp_ne_u32 vcc, s88, v102
    s_nop 1
    s_cmp_eq_u64 vcc, 0
    s_cbranch_scc1 L_fd_27
    s_add_u32 s89, s89, 1
    s_cmp_gt_u32 s89, 20000
    s_cbranch_scc1 L_fd_27
    s_sleep 8
    buffer_load_dword v102, v98, s[24:27], s49 offen sc1
    s_waitcnt vmcnt(0)
    s_branch L_fw_26
    s_nop 0
L_fd_27:
L_dp_25:
    s_barrier
    buffer_load_dwordx2 v[104:105], v97, s[24:27], s53 offen offset:0 sc1
    buffer_load_dwordx2 v[106:107], v97, s[24:27], s53 offen offset:32 sc1
    buffer_load_dwordx2 v[108:109], v97, s[24:27], s53 offen offset:64 sc1
    buffer_load_dwordx2 v[110:111], v97, s[24:27], s53 offen offset:96 sc1
    buffer_load_dwordx2 v[112:113], v97, s[24:27], s53 offen offset:128 sc1
    s_waitcnt vmcnt(5)
    v_mfma_f32_16x16x32_bf16 v[28:31], v[212:215], v[236:239], v[28:31]
    v_mfma_f32_16x16x32_bf16 v[32:35], v[216:219], v[236:239], v[32:35]
    v_mfma_f32_16x16x32_bf16 v[36:39], v[220:223], v[236:239], v[36:39]
    v_mfma_f32_16x16x32_bf16 v[40:43], v[224:227], v[236:239], v[40:43]
    v_mfma_f32_16x16x32_bf16 v[44:47], v[228:231], v[236:239], v[44:47]
    v_mfma_f32_16x16x32_bf16 v[48:51], v[212:215], v[240:243], v[48:51]
    s_nop 2
    ds_write_b128 v93, v[28:31] offset:0
    v_mfma_f32_16x16x32_bf16 v[52:55], v[216:219], v[240:243], v[52:55]
    ds_write_b128 v93, v[32:35] offset:1024
    v_mfma_f32_16x16x32_bf16 v[56:59], v[220:223], v[240:243], v[56:59]
    ds_write_b128 v93, v[36:39] offset:2048
    v_mfma_f32_16x16x32_bf16 v[60:63], v[224:227], v[240:243], v[60:63]
    ds_write_b128 v93, v[40:43] offset:3072
    v_mfma_f32_16x16x32_bf16 v[64:67], v[228:231], v[240:243], v[64:67]
    ds_write_b128 v93, v[44:47] offset:4096
    v_mfma_f32_16x16x32_bf16 v[68:71], v[212:215], v[244:247], v[68:71]
    ds_write_b128 v94, v[48:51] offset:0
    v_mfma_f32_16x16x32_bf16 v[72:75], v[216:219], v[244:247], v[72:75]
    ds_write_b128 v94, v[52:55] offset:1024
    v_mfma_f32_16x16x32_bf16 v[76:79], v[220:223], v[244:247], v[76:79]
    ds_write_b128 v94, v[56:59] offset:2048
    v_mfma_f32_16x16x32_bf16 v[80:83], v[224:227], v[244:247], v[80:83]
    ds_write_b128 v94, v[60:63] offset:3072
    v_mfma_f32_16x16x32_bf16 v[84:87], v[228:231], v[244:247], v[84:87]
    ds_write_b128 v94, v[64:67] offset:4096
    v_mfma_f32_16x16x32_bf16 v[8:11], v[212:215], v[232:235], v[8:11]
    ds_write_b128 v95, v[68:71] offset:0
    v_mfma_f32_16x16x32_bf16 v[12:15], v[216:219], v[232:235], v[12:15]
    ds_write_b128 v95, v[72:75] offset:1024
    v_mfma_f32_16x16x32_bf16 v[16:19], v[220:223], v[232:235], v[16:19]
    ds_write_b128 v95, v[76:79] offset:2048
    v_mfma_f32_16x16x32_bf16 v[20:23], v[224:227], v[232:235], v[20:23]
    ds_write_b128 v95, v[80:83] offset:3072
    v_mfma_f32_16x16x32_bf16 v[24:27], v[228:231], v[232:235], v[24:27]
    ds_write_b128 v95, v[84:87] offset:4096
    s_mul_i32 s51, s3, 15360
    v_add_u32 v96, s51, v2
    s_waitcnt lgkmcnt(0)
    s_barrier
    ds_read_b128 v[28:31], v96 offset:0
    ds_read_b128 v[48:51], v96 offset:5120
    ds_read_b128 v[68:71], v96 offset:10240
    ds_read_b128 v[32:35], v96 offset:1024
    ds_read_b128 v[52:55], v96 offset:6144
    ds_read_b128 v[72:75], v96 offset:11264
    ds_read_b128 v[36:39], v96 offset:2048
    ds_read_b128 v[56:59], v96 offset:7168
    ds_read_b128 v[76:79], v96 offset:12288
    ds_read_b128 v[40:43], v96 offset:3072
    ds_read_b128 v[60:63], v96 offset:8192
    ds_read_b128 v[80:83], v96 offset:13312
    ds_read_b128 v[44:47], v96 offset:4096
    ds_read_b128 v[64:67], v96 offset:9216
    ds_read_b128 v[84:87], v96 offset:14336
    s_waitcnt vmcnt(0)
    v_lshlrev_b32 v128, 16, v104
    v_and_b32 v129, 0xffff0000, v104
    v_lshlrev_b32 v130, 16, v105
    v_and_b32 v131, 0xffff0000, v105
    v_lshlrev_b32 v132, 16, v106
    v_and_b32 v133, 0xffff0000, v106
    v_lshlrev_b32 v134, 16, v107
    v_and_b32 v135, 0xffff0000, v107
    v_lshlrev_b32 v136, 16, v108
    v_and_b32 v137, 0xffff0000, v108
    v_lshlrev_b32 v138, 16, v109
    v_and_b32 v139, 0xffff0000, v109
    v_lshlrev_b32 v140, 16, v110
    v_and_b32 v141, 0xffff0000, v110
    v_lshlrev_b32 v142, 16, v111
    v_and_b32 v143, 0xffff0000, v111
    v_lshlrev_b32 v144, 16, v112
    v_and_b32 v145, 0xffff0000, v112
    v_lshlrev_b32 v146, 16, v113
    v_and_b32 v147, 0xffff0000, v113
    s_waitcnt lgkmcnt(12)
    v_add_f32 v8, v8, v28
    v_add_f32 v9, v9, v29
    v_add_f32 v10, v10, v30
    v_add_f32 v11, v11, v31
    v_add_f32 v8, v8, v48
    v_add_f32 v9, v9, v49
    v_add_f32 v10, v10, v50
    v_add_f32 v11, v11, v51
    v_add_f32 v8, v8, v68
    v_add_f32 v9, v9, v69
    v_add_f32 v10, v10, v70
    v_add_f32 v11, v11, v71
    v_fmac_f32 v128, v8, v101
    v_fmac_f32 v129, v9, v101
    v_fmac_f32 v130, v10, v101
    v_fmac_f32 v131, v11, v101
    v_cvt_pk_bf16_f32 v116, v128, v129
    v_cvt_pk_bf16_f32 v117, v130, v131
    buffer_store_dwordx2 v[116:117], v97, s[36:39], s52 offen offset:0
    s_waitcnt lgkmcnt(9)
    v_add_f32 v12, v12, v32
    v_add_f32 v13, v13, v33
    v_add_f32 v14, v14, v34
    v_add_f32 v15, v15, v35
    v_add_f32 v12, v12, v52
    v_add_f32 v13, v13, v53
    v_add_f32 v14, v14, v54
    v_add_f32 v15, v15, v55
    v_add_f32 v12, v12, v72
    v_add_f32 v13, v13, v73
    v_add_f32 v14, v14, v74
    v_add_f32 v15, v15, v75
    v_fmac_f32 v132, v12, v101
    v_fmac_f32 v133, v13, v101
    v_fmac_f32 v134, v14, v101
    v_fmac_f32 v135, v15, v101
    v_cvt_pk_bf16_f32 v118, v132, v133
    v_cvt_pk_bf16_f32 v119, v134, v135
    buffer_store_dwordx2 v[118:119], v97, s[36:39], s52 offen offset:32
    s_waitcnt lgkmcnt(6)
    v_add_f32 v16, v16, v36
    v_add_f32 v17, v17, v37
    v_add_f32 v18, v18, v38
    v_add_f32 v19, v19, v39
    v_add_f32 v16, v16, v56
    v_add_f32 v17, v17, v57
    v_add_f32 v18, v18, v58
    v_add_f32 v19, v19, v59
    v_add_f32 v16, v16, v76
    v_add_f32 v17, v17, v77
    v_add_f32 v18, v18, v78
    v_add_f32 v19, v19, v79
    v_fmac_f32 v136, v16, v101
    v_fmac_f32 v137, v17, v101
    v_fmac_f32 v138, v18, v101
    v_fmac_f32 v139, v19, v101
    v_cvt_pk_bf16_f32 v120, v136, v137
    v_cvt_pk_bf16_f32 v121, v138, v139
    buffer_store_dwordx2 v[120:121], v97, s[36:39], s52 offen offset:64
    s_waitcnt lgkmcnt(3)
    v_add_f32 v20, v20, v40
    v_add_f32 v21, v21, v41
    v_add_f32 v22, v22, v42
    v_add_f32 v23, v23, v43
    v_add_f32 v20, v20, v60
    v_add_f32 v21, v21, v61
    v_add_f32 v22, v22, v62
    v_add_f32 v23, v23, v63
    v_add_f32 v20, v20, v80
    v_add_f32 v21, v21, v81
    v_add_f32 v22, v22, v82
    v_add_f32 v23, v23, v83
    v_fmac_f32 v140, v20, v101
    v_fmac_f32 v141, v21, v101
    v_fmac_f32 v142, v22, v101
    v_fmac_f32 v143, v23, v101
    v_cvt_pk_bf16_f32 v122, v140, v141
    v_cvt_pk_bf16_f32 v123, v142, v143
    buffer_store_dwordx2 v[122:123], v97, s[36:39], s52 offen offset:96
    s_waitcnt lgkmcnt(0)
    v_add_f32 v24, v24, v44
    v_add_f32 v25, v25, v45
    v_add_f32 v26, v26, v46
    v_add_f32 v27, v27, v47
    v_add_f32 v24, v24, v64
    v_add_f32 v25, v25, v65
    v_add_f32 v26, v26, v66
    v_add_f32 v27, v27, v67
    v_add_f32 v24, v24, v84
    v_add_f32 v25, v25, v85
    v_add_f32 v26, v26, v86
    v_add_f32 v27, v27, v87
    v_fmac_f32 v144, v24, v101
    v_fmac_f32 v145, v25, v101
    v_fmac_f32 v146, v26, v101
    v_fmac_f32 v147, v27, v101
    v_cvt_pk_bf16_f32 v124, v144, v145
    v_cvt_pk_bf16_f32 v125, v146, v147
    buffer_store_dwordx2 v[124:125], v97, s[36:39], s52 offen offset:128
    s_endpgm
L_roleA_2:
    s_setprio 3
    s_or_b32 s40, s2, s3
    s_cmp_eq_u32 s40, 0
    s_cbranch_scc0 L_ew_28
    s_memrealtime s[40:41]
    s_waitcnt lgkmcnt(0)
    s_mul_i32 s41, s41, 0x9E3779B1
    s_xor_b32 s40, s40, s41
    s_or_b32 s40, s40, 1
    v_mov_b32 v88, s40
    v_mov_b32 v89, 0
    s_mov_b64 exec, 1
    buffer_atomic_cmpswap v[88:89], v5, s[92:95], 0 offen sc1
    s_mov_b64 exec, -1
    s_nop 0
L_ew_28:
    s_lshr_b32 s40, s2, 3
    s_and_b32 s91, s2, 1
    s_lshl_b32 s91, s91, 6
    s_add_u32 s40, s40, s91
    s_and_b32 s91, s2, 2
    s_lshl_b32 s91, s91, 4
    s_add_u32 s40, s40, s91
    s_and_b32 s91, s2, 4
    s_lshl_b32 s91, s91, 5
    s_add_u32 s40, s40, s91
    s_bfe_u32 s41, s40, 0x40003
    s_lshl_b32 s41, s41, 7
    s_lshr_b32 s43, s40, 7
    s_lshl_b32 s43, s43, 4
    s_add_u32 s41, s41, s43
    s_and_b32 s43, s40, 7
    s_lshl_b32 s43, s43, 1
    s_add_u32 s41, s41, s43
    v_and_b32 v104, 31, v1
    v_lshrrev_b32 v105, 5, v1
    s_and_b32 s42, s3, 1
    s_lshr_b32 s44, s3, 1
    s_lshl_b32 s43, s42, 6
    s_add_u32 s41, s41, s43
    s_add_u32 s41, s41, s44
    s_lshl_b32 s79, s41, 3
    s_add_u32 s79, s79, 18964480
    s_mul_i32 s41, s41, 1280
    v_mul_u32_u24 v100, 40960, v105
    v_lshl_add_u32 v100, v104, 4, v100
    v_mov_b32 v101, 1073741824
    v_cmp_gt_u32 vcc, 16, v104
    s_nop 1
    v_cndmask_b32 v101, v101, v100, vcc
    buffer_load_dwordx4 v[88:91], v100, s[28:31], s41 offen
    buffer_load_dwordx4 v[92:95], v100, s[28:31], s41 offen offset:512
    buffer_load_dwordx4 v[96:99], v101, s[28:31], s41 offen offset:1024
    s_cmp_lt_u32 s3, 2
    s_cselect_b32 s36, s6, s8
    s_cselect_b32 s37, s7, s9
    s_mov_b32 s38, 1314816
    s_mov_b32 s39, 0x00020000
    s_lshr_b32 s47, s40, 1
    s_mul_i32 s47, s47, 10272
    s_and_b32 s48, s40, 1
    s_mul_i32 s48, s48, 320
    s_add_u32 s47, s47, s48
    s_mul_i32 s48, s3, 3072
    s_mul_i32 s49, s42, 192
    v_add_u32 v100, s49, v1
    v_add_u32 v100, 0, v100
    v_mul_u32_u24 v101, 745, v100
    v_lshrrev_b32 v101, 14, v101
    v_mul_u32_u24 v102, 22, v101
    v_sub_u32 v100, v100, v102
    v_mul_u32_u24 v101, 642, v101
    v_and_b32 v101, 0xfffffff0, v101
    v_lshl_add_u32 v100, v100, 4, v101
    s_add_u32 m0, s48, 28672
    s_nop 0
    buffer_load_dwordx4 v100, s[36:39], s47 offen lds
    v_add_u32 v100, s49, v1
    v_add_u32 v100, 64, v100
    v_mul_u32_u24 v101, 745, v100
    v_lshrrev_b32 v101, 14, v101
    v_mul_u32_u24 v102, 22, v101
    v_sub_u32 v100, v100, v102
    v_mul_u32_u24 v101, 642, v101
    v_and_b32 v101, 0xfffffff0, v101
    v_lshl_add_u32 v100, v100, 4, v101
    s_add_u32 m0, s48, 29696
    s_nop 0
    buffer_load_dwordx4 v100, s[36:39], s47 offen lds
    v_add_u32 v100, s49, v1
    v_add_u32 v100, 128, v100
    v_mul_u32_u24 v101, 745, v100
    v_lshrrev_b32 v101, 14, v101
    v_mul_u32_u24 v102, 22, v101
    v_sub_u32 v100, v100, v102
    v_mul_u32_u24 v101, 642, v101
    v_and_b32 v101, 0xfffffff0, v101
    v_lshl_add_u32 v100, v100, 4, v101
    s_add_u32 m0, s48, 30720
    s_nop 0
    buffer_load_dwordx4 v100, s[36:39], s47 offen lds
    s_lshl_b32 s55, s3, 4
    v_add_u32 v146, s55, v3
    s_lshl_b32 s55, s44, 4
    s_add_u32 s55, s55, 64
    v_add_u32 v147, s55, v3
    v_cvt_f32_u32 v100, v146
    v_mul_f32 v101, 0x3acccccd, v100
    v_cos_f32 v132, v101
    v_sin_f32 v133, v101
    v_mul_f32 v101, 0x3b4ccccd, v100
    v_cos_f32 v134, v101
    v_sin_f32 v135, v101
    v_mul_f32 v101, 0x3b99999a, v100
    v_cos_f32 v136, v101
    v_sin_f32 v137, v101
    v_cvt_f32_u32 v100, v147
    v_mul_f32 v101, 0x3acccccd, v100
    v_cos_f32 v140, v101
    v_sin_f32 v141, v101
    v_mul_f32 v101, 0x3b4ccccd, v100
    v_cos_f32 v142, v101
    v_sin_f32 v143, v101
    v_mul_f32 v101, 0x3b99999a, v100
    v_cos_f32 v144, v101
    v_sin_f32 v145, v101
    v_lshlrev_b32 v102, 2, v4
    v_add_u32 v102, 16384, v102
    s_lshl_b32 s55, s42, 5
    v_add_u32 v103, s55, v102
    v_lshrrev_b32 v100, 1, v146
    v_lshl_add_u32 v148, v100, 6, v102
    v_and_b32 v100, 1, v146
    v_lshl_add_u32 v148, v100, 4, v148
    v_sub_u32 v101, 80, v146
    v_lshrrev_b32 v100, 1, v101
    v_lshl_add_u32 v149, v100, 6, v102
    v_and_b32 v100, 1, v101
    v_lshl_add_u32 v149, v100, 4, v149
    v_lshrrev_b32 v100, 1, v147
    v_lshl_add_u32 v150, v100, 6, v103
    v_and_b32 v100, 1, v147
    v_lshl_add_u32 v150, v100, 4, v150
    v_sub_u32 v101, 80, v147
    v_lshrrev_b32 v100, 1, v101
    v_lshl_add_u32 v151, v100, 6, v103
    v_and_b32 v100, 1, v101
    v_lshl_add_u32 v151, v100, 4, v151
    v_mov_b32 v101, 19456
    v_cmp_ge_u32 vcc, 80, v147
    s_nop 1
    v_cndmask_b32 v151, v101, v151, vcc
    v_mov_b32 v101, 22016
    v_cndmask_b32 v150, v101, v150, vcc
    s_mov_b64 s[70:71], vcc
    v_lshlrev_b32 v101, 9, v3
    v_add_u32 v100, 0, v4
    v_xor_b32 v100, v100, v3
    v_lshl_add_u32 v116, v100, 4, v101
    v_add_u32 v100, 4, v4
    v_xor_b32 v100, v100, v3
    v_lshl_add_u32 v117, v100, 4, v101
    v_add_u32 v100, 8, v4
    v_xor_b32 v100, v100, v3
    v_lshl_add_u32 v118, v100, 4, v101
    v_add_u32 v100, 12, v4
    v_xor_b32 v100, v100, v3
    v_lshl_add_u32 v119, v100, 4, v101
    v_add_u32 v100, 16, v4
    v_xor_b32 v100, v100, v3
    v_lshl_add_u32 v120, v100, 4, v101
    s_lshl_b32 s55, s42, 13
    v_add_u32 v124, s55, v116
    v_add_u32 v125, s55, v117
    v_add_u32 v126, s55, v118
    v_add_u32 v127, s55, v119
    v_add_u32 v128, s55, v120
    s_lshl_b32 s55, s42, 1
    v_add_u32 v100, s55, v105
    v_lshlrev_b32 v100, 2, v100
    s_lshl_b32 s55, s3, 1
    v_add_u32 v101, s55, v105
    v_lshlrev_b32 v102, 11, v101
    v_and_b32 v103, 3, v104
    v_lshl_add_u32 v102, v103, 2, v102
    v_lshrrev_b32 v103, 2, v104
    v_xor_b32 v103, v103, v100
    v_xor_b32 v100, 0, v103
    v_lshl_add_u32 v108, v100, 4, v102
    v_add_u32 v108, 0, v108
    v_xor_b32 v112, 128, v108
    v_xor_b32 v100, 1, v103
    v_lshl_add_u32 v109, v100, 4, v102
    v_add_u32 v109, 512, v109
    v_xor_b32 v113, 128, v109
    v_xor_b32 v100, 2, v103
    v_lshl_add_u32 v110, v100, 4, v102
    v_add_u32 v110, 1024, v110
    v_xor_b32 v114, 128, v110
    v_xor_b32 v100, 3, v103
    v_lshl_add_u32 v111, v100, 4, v102
    v_add_u32 v111, 1536, v111
    v_xor_b32 v115, 128, v111
    s_mov_b32 s68, 0x05040100
    s_mov_b32 s69, 0x07060302
    s_mov_b32 s67, 0x3f803f80
    s_mov_b32 s66, 0x3acccccd
    v_mov_b32 v186, 0
    v_mov_b32 v100, 0xc3200000
    v_cmp_eq_u32 vcc, 0, v146
    s_nop 1
    v_cndmask_b32 v186, v186, v100, vcc
    v_lshlrev_b32 v187, 3, v101
    v_mov_b32 v176, 0
    v_mov_b32 v177, 0
    v_cvt_f32_u32 v100, v146
    v_mul_f32 v100, 0x3bcccccd, v100
    v_cvt_f32_u32 v102, v4
    v_mul_f32 v102, v102, v100
    v_mul_f32 v102, 0x41000000, v102
    s_mov_b32 s89, 0
    s_nop 0
L_gl_29:
    v_fmamk_f32 v152, v100, 0x00000000, v102
    v_cos_f32 v153, v152
    v_sin_f32 v154, v152
    v_fmamk_f32 v155, v100, 0x3f800000, v102
    v_cos_f32 v156, v155
    v_sin_f32 v157, v155
    v_fmamk_f32 v158, v100, 0x40000000, v102
    v_cos_f32 v159, v158
    v_sin_f32 v160, v158
    v_fmamk_f32 v161, v100, 0x40400000, v102
    v_cos_f32 v162, v161
    v_sin_f32 v163, v161
    v_fmamk_f32 v164, v100, 0x40800000, v102
    v_cos_f32 v165, v164
    v_sin_f32 v166, v164
    v_fmamk_f32 v167, v100, 0x40a00000, v102
    v_cos_f32 v168, v167
    v_sin_f32 v169, v167
    v_fmamk_f32 v170, v100, 0x40c00000, v102
    v_cos_f32 v171, v170
    v_sin_f32 v172, v170
    v_fmamk_f32 v173, v100, 0x40e00000, v102
    v_cos_f32 v174, v173
    v_sin_f32 v175, v173
    v_fmamk_f32 v102, v100, 0x42000000, v102
    s_set_gpr_idx_on s89, gpr_idx(DST)
    s_nop 1
    v_cvt_pk_bf16_f32 v8, v153, v156
    v_cvt_pk_bf16_f32 v28, -v154, -v157
    v_cvt_pk_bf16_f32 v9, v159, v162
    v_cvt_pk_bf16_f32 v29, -v160, -v163
    v_cvt_pk_bf16_f32 v10, v165, v168
    v_cvt_pk_bf16_f32 v30, -v166, -v169
    v_cvt_pk_bf16_f32 v11, v171, v174
    v_cvt_pk_bf16_f32 v31, -v172, -v175
    s_set_gpr_idx_off
    s_add_u32 s89, s89, 4
    s_cmp_lt_u32 s89, 20
    s_cbranch_scc1 L_gl_29
    s_nop 0
    v_cvt_f32_u32 v100, v147
    v_mul_f32 v100, 0x3bcccccd, v100
    v_cvt_f32_u32 v102, v4
    v_mul_f32 v102, v102, v100
    v_mul_f32 v102, 0x41000000, v102
    s_mov_b32 s89, 0
    s_nop 0
L_gl_30:
    v_fmamk_f32 v152, v100, 0x00000000, v102
    v_cos_f32 v153, v152
    v_sin_f32 v154, v152
    v_fmamk_f32 v155, v100, 0x3f800000, v102
    v_cos_f32 v156, v155
    v_sin_f32 v157, v155
    v_fmamk_f32 v158, v100, 0x40000000, v102
    v_cos_f32 v159, v158
    v_sin_f32 v160, v158
    v_fmamk_f32 v161, v100, 0x40400000, v102
    v_cos_f32 v162, v161
    v_sin_f32 v163, v161
    v_fmamk_f32 v164, v100, 0x40800000, v102
    v_cos_f32 v165, v164
    v_sin_f32 v166, v164
    v_fmamk_f32 v167, v100, 0x40a00000, v102
    v_cos_f32 v168, v167
    v_sin_f32 v169, v167
    v_fmamk_f32 v170, v100, 0x40c00000, v102
    v_cos_f32 v171, v170
    v_sin_f32 v172, v170
    v_fmamk_f32 v173, v100, 0x40e00000, v102
    v_cos_f32 v174, v173
    v_sin_f32 v175, v173
    v_fmamk_f32 v102, v100, 0x42000000, v102
    s_set_gpr_idx_on s89, gpr_idx(DST)
    s_nop 1
    v_cvt_pk_bf16_f32 v48, v153, v156
    v_cvt_pk_bf16_f32 v68, -v154, -v157
    v_cvt_pk_bf16_f32 v49, v159, v162
    v_cvt_pk_bf16_f32 v69, -v160, -v163
    v_cvt_pk_bf16_f32 v50, v165, v168
    v_cvt_pk_bf16_f32 v70, -v166, -v169
    v_cvt_pk_bf16_f32 v51, v171, v174
    v_cvt_pk_bf16_f32 v71, -v172, -v175
    s_set_gpr_idx_off
    s_add_u32 s89, s89, 4
    s_cmp_lt_u32 s89, 20
    s_cbranch_scc1 L_gl_30
    s_nop 0
    s_waitcnt vmcnt(3)
    v_perm_b32 v152, v90, v88, s68
    v_perm_b32 v153, v90, v88, s69
    v_perm_b32 v154, v91, v89, s68
    v_perm_b32 v155, v91, v89, s69
    ds_write_b32 v108, v152 offset:0
    ds_write_b32 v109, v153 offset:0
    ds_write_b32 v110, v154 offset:0
    ds_write_b32 v111, v155 offset:0
    v_perm_b32 v156, v94, v92, s68
    v_perm_b32 v157, v94, v92, s69
    v_perm_b32 v158, v95, v93, s68
    v_perm_b32 v159, v95, v93, s69
    ds_write_b32 v112, v156 offset:0
    ds_write_b32 v113, v157 offset:0
    ds_write_b32 v114, v158 offset:0
    ds_write_b32 v115, v159 offset:0
    s_mov_b32 exec_lo, 0xffff
    s_mov_b32 exec_hi, 0xffff
    v_perm_b32 v160, v98, v96, s68
    v_perm_b32 v161, v98, v96, s69
    v_perm_b32 v162, v99, v97, s68
    v_perm_b32 v163, v99, v97, s69
    ds_write_b32 v108, v160 offset:256
    ds_write_b32 v109, v161 offset:256
    ds_write_b32 v110, v162 offset:256
    ds_write_b32 v111, v163 offset:256
    s_mov_b64 exec, -1
    v_dot2_f32_bf16 v176, v88, s67, v176
    v_dot2_f32_bf16 v177, v88, v88, v177
    v_dot2_f32_bf16 v176, v89, s67, v176
    v_dot2_f32_bf16 v177, v89, v89, v177
    v_dot2_f32_bf16 v176, v90, s67, v176
    v_dot2_f32_bf16 v177, v90, v90, v177
    v_dot2_f32_bf16 v176, v91, s67, v176
    v_dot2_f32_bf16 v177, v91, v91, v177
    v_dot2_f32_bf16 v176, v92, s67, v176
    v_dot2_f32_bf16 v177, v92, v92, v177
    v_dot2_f32_bf16 v176, v93, s67, v176
    v_dot2_f32_bf16 v177, v93, v93, v177
    v_dot2_f32_bf16 v176, v94, s67, v176
    v_dot2_f32_bf16 v177, v94, v94, v177
    v_dot2_f32_bf16 v176, v95, s67, v176
    v_dot2_f32_bf16 v177, v95, v95, v177
    v_dot2_f32_bf16 v176, v96, s67, v176
    v_dot2_f32_bf16 v177, v96, v96, v177
    v_dot2_f32_bf16 v176, v97, s67, v176
    v_dot2_f32_bf16 v177, v97, v97, v177
    v_dot2_f32_bf16 v176, v98, s67, v176
    v_dot2_f32_bf16 v177, v98, v98, v177
    v_dot2_f32_bf16 v176, v99, s67, v176
    v_dot2_f32_bf16 v177, v99, v99, v177
    s_nop 3
    v_add_f32_dpp v176, v176, v176 row_ror:8 row_mask:0xf bank_mask:0xf
    v_add_f32_dpp v177, v177, v177 row_ror:8 row_mask:0xf bank_mask:0xf
    s_nop 0
    v_add_f32_dpp v176, v176, v176 row_ror:4 row_mask:0xf bank_mask:0xf
    v_add_f32_dpp v177, v177, v177 row_ror:4 row_mask:0xf bank_mask:0xf
    s_nop 0
    v_add_f32_dpp v176, v176, v176 row_ror:2 row_mask:0xf bank_mask:0xf
    v_add_f32_dpp v177, v177, v177 row_ror:2 row_mask:0xf bank_mask:0xf
    s_nop 0
    v_add_f32_dpp v176, v176, v176 row_ror:1 row_mask:0xf bank_mask:0xf
    v_add_f32_dpp v177, v177, v177 row_ror:1 row_mask:0xf bank_mask:0xf
    v_mov_b32 v100, v176
    v_mov_b32 v102, v177
    s_nop 0
    v_permlane16_swap_b32 v176, v100
    v_permlane16_swap_b32 v177, v102
    v_add_f32 v176, v176, v100
    v_add_f32 v177, v177, v102
    v_mul_f32 v176, 0x3acccccd, v176
    v_mul_f32 v100, v176, v176
    v_fma_f32 v100, v177, s66, -v100
    v_max_f32 v100, 0, v100
    v_add_f32 v100, 0x3727c5ac, v100
    v_rsq_f32 v181, v100
    v_rcp_f32 v177, v100
    v_mov_b32 v180, v176
    s_mov_b32 exec_lo, 1
    s_mov_b32 exec_hi, 1
    v_lshlrev_b32 v100, 8, v105
    ds_write_b64 v187, v[180:181] offset:27648
    buffer_store_dwordx2 v[176:177], v100, s[24:27], s79 offen sc1
    s_mov_b64 exec, -1
    v_lshlrev_b32 v187, 3, v4
    s_lshl_b32 s55, s42, 5
    v_add_u32 v102, s55, v187
    s_waitcnt lgkmcnt(0)
    s_barrier
    ds_read_b64 v[180:181], v187 offset:27648
    ds_read_b64 v[182:183], v187 offset:27680
    ds_read_b64 v[184:185], v102 offset:27648
    ds_read_b128 v[188:191], v116
    ds_read_b128 v[208:211], v116 offset:8192
    ds_read_b128 v[152:155], v124
    ds_read_b128 v[192:195], v117
    ds_read_b128 v[212:215], v117 offset:8192
    ds_read_b128 v[156:159], v125
    ds_read_b128 v[196:199], v118
    ds_read_b128 v[216:219], v118 offset:8192
    ds_read_b128 v[160:163], v126
    ds_read_b128 v[200:203], v119
    ds_read_b128 v[220:223], v119 offset:8192
    ds_read_b128 v[164:167], v127
    ds_read_b128 v[204:207], v120
    ds_read_b128 v[224:227], v120 offset:8192
    ds_read_b128 v[168:171], v128
    s_mov_b32 s83, 40960
    s_bfe_u32 s51, s2, 0x20001
    s_lshl_b32 s51, s51, 2
    s_bfe_u32 s50, s2, 0x20003
    s_add_u32 s51, s51, s50
    s_bfe_u32 s52, s2, 0x10005
    s_and_b32 s53, s2, 1
    s_lshl_b32 s53, s53, 2
    s_lshr_b32 s50, s2, 6
    s_add_u32 s53, s53, s50
    s_cmp_eq_u32 s52, 0
    s_cselect_b32 s56, s12, s14
    s_cselect_b32 s57, s13, s15
    s_mov_b32 s58, 1966080
    s_mov_b32 s59, 0x00020000
    s_mul_i32 s54, s53, 245760
    s_mul_i32 s55, s51, 192
    s_add_u32 s54, s54, s55
    s_lshl_b32 s55, s3, 10
    s_add_u32 s55, s55, s83
    s_cmp_lt_u32 s2, 256
    s_cselect_b32 s54, s54, 1073741824
    v_add_u32 v88, 0, v0
    v_mul_u32_u24 v89, 683, v88
    v_lshrrev_b32 v89, 13, v89
    v_mul_u32_u24 v90, 12, v89
    v_sub_u32 v88, v88, v90
    v_mul_u32_u24 v89, 3072, v89
    v_lshl_add_u32 v88, v88, 4, v89
    s_add_u32 m0, s55, 8192
    s_nop 0
    buffer_load_dwordx4 v88, s[56:59], s54 offen lds
    v_add_u32 v88, 256, v0
    v_mul_u32_u24 v89, 683, v88
    v_lshrrev_b32 v89, 13, v89
    v_mul_u32_u24 v90, 12, v89
    v_sub_u32 v88, v88, v90
    v_mul_u32_u24 v89, 3072, v89
    v_lshl_add_u32 v88, v88, 4, v89
    s_add_u32 m0, s55, 12288
    s_nop 0
    buffer_load_dwordx4 v88, s[56:59], s54 offen lds
    v_add_u32 v88, 512, v0
    v_mul_u32_u24 v89, 683, v88
    v_lshrrev_b32 v89, 13, v89
    v_mul_u32_u24 v90, 12, v89
    v_sub_u32 v88, v88, v90
    v_mul_u32_u24 v89, 3072, v89
    v_lshl_add_u32 v88, v88, 4, v89
    s_add_u32 m0, s55, 16384
    s_nop 0
    buffer_load_dwordx4 v88, s[56:59], s54 offen lds
    v_add_u32 v88, 768, v0
    v_mul_u32_u24 v89, 683, v88
    v_lshrrev_b32 v89, 13, v89
    v_mul_u32_u24 v90, 12, v89
    v_sub_u32 v88, v88, v90
    v_mul_u32_u24 v89, 3072, v89
    v_lshl_add_u32 v88, v88, 4, v89
    s_add_u32 m0, s55, 20480
    s_cmp_eq_u32 s3, 3
    s_cselect_b32 s54, 1073741824, s54
    buffer_load_dwordx4 v88, s[56:59], s54 offen lds
    s_mov_b32 s60, s16
    s_mov_b32 s61, s17
    s_mov_b32 s62, 1966080
    s_mov_b32 s63, 0x00020000
    s_mul_i32 s64, s2, 52429
    s_lshr_b32 s64, s64, 18
    s_mul_i32 s65, s64, 5
    s_sub_u32 s65, s2, s65
    s_lshl_b32 s66, s64, 2
    s_add_u32 s66, s66, s3
    s_mul_i32 s66, s66, 10240
    s_lshl_b32 s55, s65, 8
    s_add_u32 s66, s66, s55
    s_cmp_lt_u32 s2, 240
    s_cselect_b32 s66, s66, 1073741824
    v_lshrrev_b32 v88, 1, v3
    v_xor_b32 v88, v88, v4
    v_lshlrev_b32 v88, 5, v88
    v_and_b32 v89, 1, v1
    v_lshl_add_u32 v88, v89, 4, v88
    v_mul_u32_u24 v89, 1280, v4
    v_add_u32 v90, v88, v89
    v_xor_b32 v88, 128, v88
    v_add_u32 v88, v88, v89
    v_add_u32 v88, 4096, v88
    s_lshl_b32 s55, s3, 11
    s_add_u32 m0, s55, s83
    s_nop 0
    buffer_load_dwordx4 v90, s[60:63], s66 offen lds
    buffer_load_dwordx4 v88, s[60:63], s66 offen offset:1024 lds
    buffer_load_dword v106, v5, s[92:95], 0 offen sc1
    s_waitcnt lgkmcnt(12)
    v_mfma_f32_16x16x32_bf16 v[228:231], v[188:191], v[8:11], 0
    v_mfma_f32_16x16x32_bf16 v[232:235], v[188:191], v[28:31], 0
    v_mfma_f32_16x16x32_bf16 v[236:239], v[208:211], v[8:11], 0
    v_mfma_f32_16x16x32_bf16 v[240:243], v[208:211], v[28:31], 0
    v_mfma_f32_16x16x32_bf16 v[244:247], v[152:155], v[48:51], 0
    v_mfma_f32_16x16x32_bf16 v[248:251], v[152:155], v[68:71], 0
    s_waitcnt lgkmcnt(9)
    v_mfma_f32_16x16x32_bf16 v[228:231], v[192:195], v[12:15], v[228:231]
    v_mfma_f32_16x16x32_bf16 v[232:235], v[192:195], v[32:35], v[232:235]
    v_mfma_f32_16x16x32_bf16 v[236:239], v[212:215], v[12:15], v[236:239]
    v_mfma_f32_16x16x32_bf16 v[240:243], v[212:215], v[32:35], v[240:243]
    v_mfma_f32_16x16x32_bf16 v[244:247], v[156:159], v[52:55], v[244:247]
    v_mfma_f32_16x16x32_bf16 v[248:251], v[156:159], v[72:75], v[248:251]
    s_waitcnt lgkmcnt(6)
    v_mfma_f32_16x16x32_bf16 v[228:231], v[196:199], v[16:19], v[228:231]
    v_mfma_f32_16x16x32_bf16 v[232:235], v[196:199], v[36:39], v[232:235]
    v_mfma_f32_16x16x32_bf16 v[236:239], v[216:219], v[16:19], v[236:239]
    v_mfma_f32_16x16x32_bf16 v[240:243], v[216:219], v[36:39], v[240:243]
    v_mfma_f32_16x16x32_bf16 v[244:247], v[160:163], v[56:59], v[244:247]
    v_mfma_f32_16x16x32_bf16 v[248:251], v[160:163], v[76:79], v[248:251]
    s_waitcnt lgkmcnt(3)
    v_mfma_f32_16x16x32_bf16 v[228:231], v[200:203], v[20:23], v[228:231]
    v_mfma_f32_16x16x32_bf16 v[232:235], v[200:203], v[40:43], v[232:235]
    v_mfma_f32_16x16x32_bf16 v[236:239], v[220:223], v[20:23], v[236:239]
    v_mfma_f32_16x16x32_bf16 v[240:243], v[220:223], v[40:43], v[240:243]
    v_mfma_f32_16x16x32_bf16 v[244:247], v[164:167], v[60:63], v[244:247]
    v_mfma_f32_16x16x32_bf16 v[248:251], v[164:167], v[80:83], v[248:251]
    s_waitcnt lgkmcnt(0)
    v_mfma_f32_16x16x32_bf16 v[228:231], v[204:207], v[24:27], v[228:231]
    v_mfma_f32_16x16x32_bf16 v[232:235], v[204:207], v[44:47], v[232:235]
    v_mfma_f32_16x16x32_bf16 v[236:239], v[224:227], v[24:27], v[236:239]
    v_mfma_f32_16x16x32_bf16 v[240:243], v[224:227], v[44:47], v[240:243]
    v_mfma_f32_16x16x32_bf16 v[244:247], v[168:171], v[64:67], v[244:247]
    v_mfma_f32_16x16x32_bf16 v[248:251], v[168:171], v[84:87], v[248:251]
    s_nop 2
    v_fmac_f32 v228, v180, v186
    v_fmac_f32 v229, v180, v186
    v_fmac_f32 v230, v180, v186
    v_fmac_f32 v231, v180, v186
    v_mul_f32 v228, v228, v181
    v_mul_f32 v229, v229, v181
    v_mul_f32 v230, v230, v181
    v_mul_f32 v231, v231, v181
    v_mul_f32 v232, v232, v181
    v_mul_f32 v233, v233, v181
    v_mul_f32 v234, v234, v181
    v_mul_f32 v235, v235, v181
    v_mul_f32 v190, v229, v132
    v_mul_f32 v191, v233, v132
    v_fmac_f32 v190, v233, v133
    v_fma_f32 v191, -v229, v133, v191
    v_mul_f32 v192, v230, v134
    v_mul_f32 v193, v234, v134
    v_fmac_f32 v192, v234, v135
    v_fma_f32 v193, -v230, v135, v193
    v_mul_f32 v194, v231, v136
    v_mul_f32 v195, v235, v136
    v_fmac_f32 v194, v235, v137
    v_fma_f32 v195, -v231, v137, v195
    v_add_f32 v196, v228, v192
    v_add_f32 v197, v232, v193
    v_sub_f32 v198, v228, v192
    v_sub_f32 v199, v232, v193
    v_add_f32 v200, v190, v194
    v_add_f32 v201, v191, v195
    v_sub_f32 v202, v190, v194
    v_sub_f32 v203, v191, v195
    v_add_f32 v188, v196, v200
    v_add_f32 v189, v197, v201
    v_add_f32 v190, v198, v203
    v_sub_f32 v191, v199, v202
    v_sub_f32 v192, v196, v200
    v_sub_f32 v193, v201, v197
    v_sub_f32 v194, v198, v203
    v_add_f32 v195, v199, v202
    v_cvt_pk_bf16_f32 v204, v188, v189
    v_cvt_pk_bf16_f32 v205, v190, v191
    v_cvt_pk_bf16_f32 v206, v192, v193
    v_cvt_pk_bf16_f32 v207, v194, -v195
    ds_write_b32 v149, v207 offset:2560
    ds_write_b32 v149, v206 offset:7680
    ds_write_b32 v148, v204 offset:0
    ds_write_b32 v148, v205 offset:5120
    v_fmac_f32 v236, v182, v186
    v_fmac_f32 v237, v182, v186
    v_fmac_f32 v238, v182, v186
    v_fmac_f32 v239, v182, v186
    v_mul_f32 v236, v236, v183
    v_mul_f32 v237, v237, v183
    v_mul_f32 v238, v238, v183
    v_mul_f32 v239, v239, v183
    v_mul_f32 v240, v240, v183
    v_mul_f32 v241, v241, v183
    v_mul_f32 v242, v242, v183
    v_mul_f32 v243, v243, v183
    v_mul_f32 v210, v237, v132
    v_mul_f32 v211, v241, v132
    v_fmac_f32 v210, v241, v133
    v_fma_f32 v211, -v237, v133, v211
    v_mul_f32 v212, v238, v134
    v_mul_f32 v213, v242, v134
    v_fmac_f32 v212, v242, v135
    v_fma_f32 v213, -v238, v135, v213
    v_mul_f32 v214, v239, v136
    v_mul_f32 v215, v243, v136
    v_fmac_f32 v214, v243, v137
    v_fma_f32 v215, -v239, v137, v215
    v_add_f32 v216, v236, v212
    v_add_f32 v217, v240, v213
    v_sub_f32 v218, v236, v212
    v_sub_f32 v219, v240, v213
    v_add_f32 v220, v210, v214
    v_add_f32 v221, v211, v215
    v_sub_f32 v222, v210, v214
    v_sub_f32 v223, v211, v215
    v_add_f32 v208, v216, v220
    v_add_f32 v209, v217, v221
    v_add_f32 v210, v218, v223
    v_sub_f32 v211, v219, v222
    v_sub_f32 v212, v216, v220
    v_sub_f32 v213, v221, v217
    v_sub_f32 v214, v218, v223
    v_add_f32 v215, v219, v222
    v_cvt_pk_bf16_f32 v224, v208, v209
    v_cvt_pk_bf16_f32 v225, v210, v211
    v_cvt_pk_bf16_f32 v226, v212, v213
    v_cvt_pk_bf16_f32 v227, v214, -v215
    ds_write_b32 v149, v227 offset:2592
    ds_write_b32 v149, v226 offset:7712
    ds_write_b32 v148, v224 offset:32
    ds_write_b32 v148, v225 offset:5152
    v_mul_f32 v244, v244, v185
    v_mul_f32 v245, v245, v185
    v_mul_f32 v246, v246, v185
    v_mul_f32 v247, v247, v185
    v_mul_f32 v248, v248, v185
    v_mul_f32 v249, v249, v185
    v_mul_f32 v250, v250, v185
    v_mul_f32 v251, v251, v185
    v_mul_f32 v10, v245, v140
    v_mul_f32 v11, v249, v140
    v_fmac_f32 v10, v249, v141
    v_fma_f32 v11, -v245, v141, v11
    v_mul_f32 v12, v246, v142
    v_mul_f32 v13, v250, v142
    v_fmac_f32 v12, v250, v143
    v_fma_f32 v13, -v246, v143, v13
    v_mul_f32 v14, v247, v144
    v_mul_f32 v15, v251, v144
    v_fmac_f32 v14, v251, v145
    v_fma_f32 v15, -v247, v145, v15
    v_add_f32 v16, v244, v12
    v_add_f32 v17, v248, v13
    v_sub_f32 v18, v244, v12
    v_sub_f32 v19, v248, v13
    v_add_f32 v20, v10, v14
    v_add_f32 v21, v11, v15
    v_sub_f32 v22, v10, v14
    v_sub_f32 v23, v11, v15
    v_add_f32 v8, v16, v20
    v_add_f32 v9, v17, v21
    v_add_f32 v10, v18, v23
    v_sub_f32 v11, v19, v22
    v_sub_f32 v12, v16, v20
    v_sub_f32 v13, v21, v17
    v_sub_f32 v14, v18, v23
    v_add_f32 v15, v19, v22
    v_cvt_pk_bf16_f32 v24, v8, v9
    v_cvt_pk_bf16_f32 v25, v10, v11
    v_cvt_pk_bf16_f32 v26, v12, v13
    v_cvt_pk_bf16_f32 v27, v14, -v15
    s_mov_b64 exec, s[70:71]
    ds_write_b32 v151, v27 offset:2560
    ds_write_b32 v151, v26 offset:7680
    ds_write_b32 v150, v24 offset:0
    ds_write_b32 v150, v25 offset:5120
    s_mov_b64 exec, -1
    v_lshrrev_b32 v100, 2, v0
    v_mul_u32_u24 v48, 16512, v100
    v_and_b32 v100, 3, v0
    v_lshl_add_u32 v48, v100, 4, v48
    v_lshlrev_b32 v53, 4, v0
    v_lshrrev_b32 v100, 3, v0
    v_mul_u32_u24 v49, 16512, v100
    v_and_b32 v101, 7, v0
    v_lshl_add_u32 v49, v101, 4, v49
    v_mul_u32_u24 v50, 704, v101
    v_lshl_add_u32 v50, v100, 2, v50
    v_and_b32 v101, 3, v101
    v_lshl_add_u32 v50, v101, 2, v50
    s_and_b32 s55, s40, 1
    v_mov_b32 v101, 1073741824
    v_cmp_gt_u32 vcc, 132, v0
    s_nop 1
    v_cndmask_b32 v51, v101, v48, vcc
    v_cmp_gt_u32 vcc, 136, v0
    s_nop 1
    v_cndmask_b32 v52, v101, v49, vcc
    s_lshl_b32 s72, s40, 6
    s_add_u32 s72, s72, 8257536
    s_add_u32 s73, s72, 1056768
    s_add_u32 s74, s72, 2113536
    s_lshr_b32 s75, s40, 1
    s_lshl_b32 s75, s75, 7
    s_mul_i32 s55, s55, 1320960
    s_add_u32 s75, s75, s55
    s_add_u32 s75, s75, 10919936
    s_add_u32 s76, s75, 528384
    s_add_u32 s77, s75, 1056768
    s_waitcnt vmcnt(8) lgkmcnt(0)
    s_barrier
    ds_read_b128 v[56:59], v53 offset:16384
    ds_read_b128 v[60:63], v53 offset:20480
    ds_read_b128 v[64:67], v53 offset:24576
    ds_read_u16 v8, v50 offset:28672
    ds_read_u16 v12, v50 offset:34816
    ds_read_u16 v9, v50 offset:28674
    ds_read_u16 v13, v50 offset:34818
    ds_read_u16 v10, v50 offset:29026
    ds_read_u16 v14, v50 offset:35170
    ds_read_u16 v11, v50 offset:29028
    ds_read_u16 v15, v50 offset:35172
    s_waitcnt lgkmcnt(10)
    buffer_store_dwordx4 v[56:59], v48, s[24:27], s72 offen sc1
    s_waitcnt lgkmcnt(9)
    buffer_store_dwordx4 v[60:63], v48, s[24:27], s73 offen sc1
    s_waitcnt lgkmcnt(8)
    buffer_store_dwordx4 v[64:67], v51, s[24:27], s74 offen sc1
    s_waitcnt lgkmcnt(0)
    ds_read_u16 v20, v50 offset:28800
    ds_read_u16 v24, v50 offset:34944
    ds_read_u16 v21, v50 offset:28802
    ds_read_u16 v25, v50 offset:34946
    ds_read_u16 v22, v50 offset:29154
    ds_read_u16 v26, v50 offset:35298
    ds_read_u16 v23, v50 offset:29156
    ds_read_u16 v27, v50 offset:35300
    v_lshl_or_b32 v16, v12, 16, v8
    v_lshl_or_b32 v17, v13, 16, v9
    v_lshl_or_b32 v18, v14, 16, v10
    v_lshl_or_b32 v19, v15, 16, v11
    buffer_store_dwordx4 v[16:19], v49, s[24:27], s75 offen sc1
    s_waitcnt lgkmcnt(0)
    ds_read_u16 v32, v50 offset:28928
    ds_read_u16 v36, v50 offset:35072
    ds_read_u16 v33, v50 offset:28930
    ds_read_u16 v37, v50 offset:35074
    ds_read_u16 v34, v50 offset:29282
    ds_read_u16 v38, v50 offset:35426
    ds_read_u16 v35, v50 offset:29284
    ds_read_u16 v39, v50 offset:35428
    v_lshl_or_b32 v28, v24, 16, v20
    v_lshl_or_b32 v29, v25, 16, v21
    v_lshl_or_b32 v30, v26, 16, v22
    v_lshl_or_b32 v31, v27, 16, v23
    buffer_store_dwordx4 v[28:31], v49, s[24:27], s76 offen sc1
    s_waitcnt lgkmcnt(0)
    v_lshl_or_b32 v40, v36, 16, v32
    v_lshl_or_b32 v41, v37, 16, v33
    v_lshl_or_b32 v42, v38, 16, v34
    v_lshl_or_b32 v43, v39, 16, v35
    buffer_store_dwordx4 v[40:43], v52, s[24:27], s77 offen sc1
    s_waitcnt vmcnt(6)
    s_barrier
    s_mov_b32 s89, 0
    s_nop 0
L_eg_31:
    v_readfirstlane_b32 s88, v106
    s_nop 1
    s_cmp_lg_u32 s88, 0
    s_cbranch_scc1 L_ed_32
    s_add_u32 s89, s89, 1
    s_cmp_gt_u32 s89, 20000
    s_cbranch_scc1 L_ed_32
    s_sleep 8
    buffer_load_dword v106, v5, s[92:95], 0 offen sc1
    s_waitcnt vmcnt(0)
    s_branch L_eg_31
    s_nop 0
L_ed_32:
    s_lshl_b32 s78, s2, 7
    s_add_u32 s78, s78, 18980864
    s_bfe_u32 s79, s40, 0x40003
    s_lshl_b32 s79, s79, 4
    s_lshr_b32 s91, s40, 7
    s_lshl_b32 s91, s91, 3
    s_add_u32 s79, s79, s91
    s_and_b32 s91, s40, 7
    s_add_u32 s79, s79, s91
    s_lshl_b32 s79, s79, 7
    s_add_u32 s79, s79, 19013632
    v_lshrrev_b32 v92, 5, v1
    v_lshlrev_b32 v93, 4, v0
    v_add_u32 v93, 32768, v93
    s_bfe_u32 s51, s2, 0x20001
    s_lshl_b32 s51, s51, 2
    s_bfe_u32 s50, s2, 0x20003
    s_add_u32 s51, s51, s50
    s_bfe_u32 s52, s2, 0x10005
    s_and_b32 s53, s2, 1
    s_lshl_b32 s53, s53, 2
    s_lshr_b32 s50, s2, 6
    s_add_u32 s53, s53, s50
    s_mul_i32 s64, s2, 52429
    s_lshr_b32 s64, s64, 18
    s_mul_i32 s65, s64, 5
    s_sub_u32 s65, s2, s65
    v_mul_u32_u24 v89, 171, v0
    v_lshrrev_b32 v89, 12, v89
    v_mul_u32_u24 v88, 24, v89
    v_sub_u32 v88, v0, v88
    v_mul_u32_u24 v89, 1536, v89
    v_lshl_add_u32 v88, v88, 3, v89
    v_min_u32 v88, 14848, v88
    v_add_u32 v88, s83, v88
    ds_read_b64 v[96:97], v88 offset:8192
    ds_read_b64 v[98:99], v88 offset:8384
    ds_read_b64 v[100:101], v88 offset:8576
    ds_read_b64 v[102:103], v88 offset:8768
    ds_read_b64 v[104:105], v88 offset:8960
    ds_read_b64 v[106:107], v88 offset:9152
    ds_read_b64 v[108:109], v88 offset:9344
    ds_read_b64 v[110:111], v88 offset:9536
    v_lshrrev_b32 v89, 2, v3
    v_and_b32 v90, 1, v4
    v_lshl_add_u32 v89, v90, 2, v89
    s_lshl_b32 s55, s3, 1
    v_xor_b32 v90, s55, v89
    v_lshlrev_b32 v90, 5, v90
    v_lshl_add_u32 v90, v89, 8, v90
    v_lshl_add_u32 v90, v92, 12, v90
    v_and_b32 v89, 3, v1
    v_lshl_add_u32 v90, v89, 3, v90
    v_add_u32 v90, s83, v90
    v_xor_b32 v91, 32, v90
    ds_read_b64_tr_b16 v[112:113], v90
    ds_read_b64_tr_b16 v[114:115], v90 offset:2048
    ds_read_b64_tr_b16 v[116:117], v91
    ds_read_b64_tr_b16 v[118:119], v91 offset:2048
    s_lshl_b32 s67, s65, 3
    s_add_u32 s67, s67, s55
    s_add_u32 s67, s67, 0
    s_mul_i32 s68, s67, 52
    s_lshr_b32 s68, s68, 8
    s_mul_i32 s69, s68, 235
    s_add_u32 s67, s67, s69
    s_mul_i32 s69, s64, 5
    s_add_u32 s67, s67, s69
    s_lshl_b32 s67, s67, 10
    s_add_u32 s67, s67, 0
    s_cmp_lt_u32 s2, 240
    s_cselect_b32 s72, s67, 1073741824
    s_lshl_b32 s67, s65, 3
    s_add_u32 s67, s67, s55
    s_add_u32 s67, s67, 1
    s_mul_i32 s68, s67, 52
    s_lshr_b32 s68, s68, 8
    s_mul_i32 s69, s68, 235
    s_add_u32 s67, s67, s69
    s_mul_i32 s69, s64, 5
    s_add_u32 s67, s67, s69
    s_lshl_b32 s67, s67, 10
    s_add_u32 s67, s67, 0
    s_cmp_lt_u32 s2, 240
    s_cselect_b32 s73, s67, 1073741824
    s_waitcnt lgkmcnt(4)
    v_lshlrev_b32 v120, 16, v96
    v_and_b32 v121, 0xffff0000, v96
    v_lshlrev_b32 v122, 16, v97
    v_and_b32 v123, 0xffff0000, v97
    v_lshlrev_b32 v88, 16, v98
    v_and_b32 v89, 0xffff0000, v98
    v_add_f32 v120, v120, v88
    v_add_f32 v121, v121, v89
    v_lshlrev_b32 v88, 16, v99
    v_and_b32 v89, 0xffff0000, v99
    v_add_f32 v122, v122, v88
    v_add_f32 v123, v123, v89
    v_lshlrev_b32 v88, 16, v100
    v_and_b32 v89, 0xffff0000, v100
    v_add_f32 v120, v120, v88
    v_add_f32 v121, v121, v89
    v_lshlrev_b32 v88, 16, v101
    v_and_b32 v89, 0xffff0000, v101
    v_add_f32 v122, v122, v88
    v_add_f32 v123, v123, v89
    v_lshlrev_b32 v88, 16, v102
    v_and_b32 v89, 0xffff0000, v102
    v_add_f32 v120, v120, v88
    v_add_f32 v121, v121, v89
    v_lshlrev_b32 v88, 16, v103
    v_and_b32 v89, 0xffff0000, v103
    v_add_f32 v122, v122, v88
    v_add_f32 v123, v123, v89
    v_lshlrev_b32 v88, 16, v104
    v_and_b32 v89, 0xffff0000, v104
    v_add_f32 v120, v120, v88
    v_add_f32 v121, v121, v89
    v_lshlrev_b32 v88, 16, v105
    v_and_b32 v89, 0xffff0000, v105
    v_add_f32 v122, v122, v88
    v_add_f32 v123, v123, v89
    v_lshlrev_b32 v88, 16, v106
    v_and_b32 v89, 0xffff0000, v106
    v_add_f32 v120, v120, v88
    v_add_f32 v121, v121, v89
    v_lshlrev_b32 v88, 16, v107
    v_and_b32 v89, 0xffff0000, v107
    v_add_f32 v122, v122, v88
    v_add_f32 v123, v123, v89
    v_lshlrev_b32 v88, 16, v108
    v_and_b32 v89, 0xffff0000, v108
    v_add_f32 v120, v120, v88
    v_add_f32 v121, v121, v89
    v_lshlrev_b32 v88, 16, v109
    v_and_b32 v89, 0xffff0000, v109
    v_add_f32 v122, v122, v88
    v_add_f32 v123, v123, v89
    v_lshlrev_b32 v88, 16, v110
    v_and_b32 v89, 0xffff0000, v110
    v_add_f32 v120, v120, v88
    v_add_f32 v121, v121, v89
    v_lshlrev_b32 v88, 16, v111
    v_and_b32 v89, 0xffff0000, v111
    v_add_f32 v122, v122, v88
    v_add_f32 v123, v123, v89
    ds_write_b128 v93, v[120:123] offset:40960
    s_waitcnt lgkmcnt(1)
    buffer_store_dwordx4 v[112:115], v2, s[24:27], s72 offen sc1
    buffer_store_dwordx4 v[116:119], v2, s[24:27], s73 offen sc1
    v_lshlrev_b32 v88, 2, v0
    v_mov_b32 v89, 1073741824
    v_cmp_gt_u32 vcc, 96, v0
    s_nop 1
    v_cndmask_b32 v89, v89, v88, vcc
    s_lshl_b32 s74, s53, 1
    s_add_u32 s74, s74, s52
    s_mul_i32 s74, s74, 6144
    s_mul_i32 s55, s51, 384
    s_add_u32 s74, s74, s55
    s_add_u32 s74, s74, 18866176
    s_cmp_lt_u32 s2, 256
    s_cselect_b32 s74, s74, 1073741824
    v_add_u32 v88, 32768, v88
    s_waitcnt lgkmcnt(0)
    s_barrier
    ds_read_b32 v96, v88 offset:40960
    ds_read_b32 v97, v88 offset:41344
    ds_read_b32 v98, v88 offset:41728
    ds_read_b32 v99, v88 offset:42112
    ds_read_b32 v100, v88 offset:42496
    ds_read_b32 v101, v88 offset:42880
    ds_read_b32 v102, v88 offset:43264
    ds_read_b32 v103, v88 offset:43648
    ds_read_b32 v104, v88 offset:44032
    ds_read_b32 v105, v88 offset:44416
    s_waitcnt lgkmcnt(0)
    v_add_f32 v96, v96, v97
    v_add_f32 v96, v96, v98
    v_add_f32 v96, v96, v99
    v_add_f32 v96, v96, v100
    v_add_f32 v96, v96, v101
    v_add_f32 v96, v96, v102
    v_add_f32 v96, v96, v103
    v_add_f32 v96, v96, v104
    v_add_f32 v96, v96, v105
    buffer_store_dword v96, v89, s[24:27], s74 offen sc1
    s_lshl_b32 s77, s51, 1
    s_add_u32 s77, s77, s52
    s_lshl_b32 s77, s77, 3
    s_add_u32 s77, s77, s53
    s_lshl_b32 s77, s77, 7
    s_add_u32 s77, s77, 19046400
    s_waitcnt vmcnt(0)
    s_barrier
    s_cmp_eq_u32 s3, 0
    s_cbranch_scc0 L_pb_35
    v_mov_b32 v216, s88
    s_mov_b64 exec, 1
    buffer_store_dword v216, v5, s[24:27], s78 offen sc0 sc1
    buffer_store_dword v216, v5, s[24:27], s79 offen sc0 sc1
    buffer_store_dword v216, v5, s[24:27], s77 offen sc0 sc1
    s_mov_b64 exec, -1
    s_nop 0
L_pb_35:
    s_cmp_ge_u32 s2, 161
    s_cbranch_scc1 L_fskip_33
    s_mul_i32 s84, s2, 16512
    s_lshl_b32 s41, s3, 12
    s_add_u32 s40, s84, s41
    s_add_u32 s40, s40, 8257536
    v_and_b32 v216, 1, v1
    v_lshlrev_b32 v235, 13, v216
    v_lshrrev_b32 v216, 1, v1
    v_lshl_add_u32 v235, v216, 4, v235
    s_lshl_b32 s41, s3, 11
    v_add_u32 v235, s41, v235
    s_add_u32 s44, s84, 10919936
    s_add_u32 s45, s44, 8192
    s_lshl_b32 s85, s3, 11
    s_add_u32 s46, s84, s85
    s_add_u32 s46, s46, 13582336
    s_add_u32 s47, s46, 8192
    s_lshl_b32 s80, s3, 4
    v_add_u32 v233, s80, v3
    v_lshlrev_b32 v232, 3, v233
    v_lshl_add_u32 v232, v4, 11, v232
    v_and_b32 v234, 31, v1
    v_lshlrev_b32 v234, 5, v234
    v_lshrrev_b32 v216, 5, v1
    v_lshl_add_u32 v234, v216, 4, v234
    s_mov_b32 s48, 18980864
    v_cvt_f32_u32 v216, v233
    v_mul_f32 v216, 0x3a000000, v216
    v_lshlrev_b32 v217, 2, v4
    v_add_u32 v218, 0, v217
    v_cvt_f32_u32 v218, v218
    v_mul_f32 v218, v218, v216
    v_cos_f32 v24, v218
    v_sin_f32 v25, v218
    v_add_u32 v218, 1, v217
    v_cvt_f32_u32 v218, v218
    v_mul_f32 v218, v218, v216
    v_cos_f32 v26, v218
    v_sin_f32 v27, v218
    v_add_u32 v218, 2, v217
    v_cvt_f32_u32 v218, v218
    v_mul_f32 v218, v218, v216
    v_cos_f32 v28, v218
    v_sin_f32 v29, v218
    v_add_u32 v218, 3, v217
    v_cvt_f32_u32 v218, v218
    v_mul_f32 v218, v218, v216
    v_cos_f32 v30, v218
    v_sin_f32 v31, v218
    v_add_u32 v218, 16, v217
    v_cvt_f32_u32 v218, v218
    v_mul_f32 v218, v218, v216
    v_cos_f32 v32, v218
    v_sin_f32 v33, v218
    v_add_u32 v218, 17, v217
    v_cvt_f32_u32 v218, v218
    v_mul_f32 v218, v218, v216
    v_cos_f32 v34, v218
    v_sin_f32 v35, v218
    v_add_u32 v218, 18, v217
    v_cvt_f32_u32 v218, v218
    v_mul_f32 v218, v218, v216
    v_cos_f32 v36, v218
    v_sin_f32 v37, v218
    v_add_u32 v218, 19, v217
    v_cvt_f32_u32 v218, v218
    v_mul_f32 v218, v218, v216
    v_cos_f32 v38, v218
    v_sin_f32 v39, v218
    v_lshrrev_b32 v218, 2, v233
    v_and_b32 v219, 3, v233
    v_lshlrev_b32 v219, 2, v219
    v_add_u32 v220, 0, v217
    v_xor_b32 v221, v218, v220
    v_lshl_add_u32 v221, v221, 4, v219
    v_lshl_add_u32 v224, v220, 8, v221
    v_add_u32 v220, 1, v217
    v_xor_b32 v221, v218, v220
    v_lshl_add_u32 v221, v221, 4, v219
    v_lshl_add_u32 v225, v220, 8, v221
    v_add_u32 v220, 2, v217
    v_xor_b32 v221, v218, v220
    v_lshl_add_u32 v221, v221, 4, v219
    v_lshl_add_u32 v226, v220, 8, v221
    v_add_u32 v220, 3, v217
    v_xor_b32 v221, v218, v220
    v_lshl_add_u32 v221, v221, 4, v219
    v_lshl_add_u32 v227, v220, 8, v221
    v_lshlrev_b32 v217, 8, v3
    v_add_u32 v216, 0, v4
    v_xor_b32 v216, v216, v3
    v_lshl_add_u32 v228, v216, 4, v217
    v_add_u32 v216, 4, v4
    v_xor_b32 v216, v216, v3
    v_lshl_add_u32 v229, v216, 4, v217
    v_add_u32 v216, 8, v4
    v_xor_b32 v216, v216, v3
    v_lshl_add_u32 v230, v216, 4, v217
    v_add_u32 v216, 12, v4
    v_xor_b32 v216, v216, v3
    v_lshl_add_u32 v231, v216, 4, v217
    v_cvt_f32_u32 v216, v233
    v_mul_f32 v216, 0x3c800000, v216
    v_cvt_f32_u32 v218, v4
    v_mul_f32 v218, 4.0, v218
    v_mul_f32 v217, v218, v216
    s_mov_b32 s89, 0
    s_nop 0
L_gl_36:
    v_fmamk_f32 v40, v216, 0x00000000, v217
    v_cos_f32 v41, v40
    v_sin_f32 v42, v40
    v_fmamk_f32 v43, v216, 0x3f800000, v217
    v_cos_f32 v44, v43
    v_sin_f32 v45, v43
    v_fmamk_f32 v46, v216, 0x40000000, v217
    v_cos_f32 v47, v46
    v_sin_f32 v48, v46
    v_fmamk_f32 v49, v216, 0x40400000, v217
    v_cos_f32 v50, v49
    v_sin_f32 v51, v49
    v_fmamk_f32 v217, v216, 0x41800000, v217
    s_set_gpr_idx_on s89, gpr_idx(DST)
    s_nop 1
    v_cvt_pk_bf16_f32 v128, v41, v42
    v_cvt_pk_bf16_f32 v144, -v42, v41
    v_cvt_pk_bf16_f32 v129, v44, v45
    v_cvt_pk_bf16_f32 v145, -v45, v44
    v_cvt_pk_bf16_f32 v130, v47, v48
    v_cvt_pk_bf16_f32 v146, -v48, v47
    v_cvt_pk_bf16_f32 v131, v50, v51
    v_cvt_pk_bf16_f32 v147, -v51, v50
    s_set_gpr_idx_off
    s_add_u32 s89, s89, 4
    s_cmp_lt_u32 s89, 16
    s_cbranch_scc1 L_gl_36
    s_nop 0
    v_and_b32 v219, 12, v3
    v_bfe_u32 v220, v1, 1, 1
    v_add_u32 v219, v219, v220
    v_and_b32 v220, 1, v1
    v_cvt_f32_u32 v220, v220
    v_mul_f32 v220, 0x3e800000, v220
    v_add_u32 v216, 0, v219
    v_cvt_f32_u32 v216, v216
    v_mul_f32 v216, 0x3d000000, v216
    v_fma_f32 v217, v218, v216, v220
    s_mov_b32 s89, 0
    s_nop 0
L_gl_37:
    v_fmamk_f32 v40, v216, 0x00000000, v217
    v_cos_f32 v41, v40
    v_sin_f32 v42, v40
    v_fmamk_f32 v43, v216, 0x3f800000, v217
    v_cos_f32 v44, v43
    v_sin_f32 v45, v43
    v_fmamk_f32 v46, v216, 0x40000000, v217
    v_cos_f32 v47, v46
    v_sin_f32 v48, v46
    v_fmamk_f32 v49, v216, 0x40400000, v217
    v_cos_f32 v50, v49
    v_sin_f32 v51, v49
    v_fmamk_f32 v217, v216, 0x41800000, v217
    s_set_gpr_idx_on s89, gpr_idx(DST)
    s_nop 1
    v_cvt_pk_bf16_f32 v160, v41, v42
    v_cvt_pk_bf16_f32 v161, v44, v45
    v_cvt_pk_bf16_f32 v162, v47, v48
    v_cvt_pk_bf16_f32 v163, v50, v51
    s_set_gpr_idx_off
    s_add_u32 s89, s89, 4
    s_cmp_lt_u32 s89, 8
    s_cbranch_scc1 L_gl_37
    s_nop 0
    v_add_u32 v216, 2, v219
    v_cvt_f32_u32 v216, v216
    v_mul_f32 v216, 0x3d000000, v216
    v_fma_f32 v217, v218, v216, v220
    s_mov_b32 s89, 0
    s_nop 0
L_gl_38:
    v_fmamk_f32 v40, v216, 0x00000000, v217
    v_cos_f32 v41, v40
    v_sin_f32 v42, v40
    v_fmamk_f32 v43, v216, 0x3f800000, v217
    v_cos_f32 v44, v43
    v_sin_f32 v45, v43
    v_fmamk_f32 v46, v216, 0x40000000, v217
    v_cos_f32 v47, v46
    v_sin_f32 v48, v46
    v_fmamk_f32 v49, v216, 0x40400000, v217
    v_cos_f32 v50, v49
    v_sin_f32 v51, v49
    v_fmamk_f32 v217, v216, 0x41800000, v217
    s_set_gpr_idx_on s89, gpr_idx(DST)
    s_nop 1
    v_cvt_pk_bf16_f32 v168, v41, v42
    v_cvt_pk_bf16_f32 v169, v44, v45
    v_cvt_pk_bf16_f32 v170, v47, v48
    v_cvt_pk_bf16_f32 v171, v50, v51
    s_set_gpr_idx_off
    s_add_u32 s89, s89, 4
    s_cmp_lt_u32 s89, 8
    s_cbranch_scc1 L_gl_38
    s_nop 0
    v_add_u32 v216, 16, v219
    v_cvt_f32_u32 v216, v216
    v_mul_f32 v216, 0x3d000000, v216
    v_fma_f32 v217, v218, v216, v220
    s_mov_b32 s89, 0
    s_nop 0
L_gl_39:
    v_fmamk_f32 v40, v216, 0x00000000, v217
    v_cos_f32 v41, v40
    v_sin_f32 v42, v40
    v_fmamk_f32 v43, v216, 0x3f800000, v217
    v_cos_f32 v44, v43
    v_sin_f32 v45, v43
    v_fmamk_f32 v46, v216, 0x40000000, v217
    v_cos_f32 v47, v46
    v_sin_f32 v48, v46
    v_fmamk_f32 v49, v216, 0x40400000, v217
    v_cos_f32 v50, v49
    v_sin_f32 v51, v49
    v_fmamk_f32 v217, v216, 0x41800000, v217
    s_set_gpr_idx_on s89, gpr_idx(DST)
    s_nop 1
    v_cvt_pk_bf16_f32 v176, v41, v42
    v_cvt_pk_bf16_f32 v177, v44, v45
    v_cvt_pk_bf16_f32 v178, v47, v48
    v_cvt_pk_bf16_f32 v179, v50, v51
    s_set_gpr_idx_off
    s_add_u32 s89, s89, 4
    s_cmp_lt_u32 s89, 8
    s_cbranch_scc1 L_gl_39
    s_nop 0
    v_add_u32 v216, 18, v219
    v_cvt_f32_u32 v216, v216
    v_mul_f32 v216, 0x3d000000, v216
    v_fma_f32 v217, v218, v216, v220
    s_mov_b32 s89, 0
    s_nop 0
L_gl_40:
    v_fmamk_f32 v40, v216, 0x00000000, v217
    v_cos_f32 v41, v40
    v_sin_f32 v42, v40
    v_fmamk_f32 v43, v216, 0x3f800000, v217
    v_cos_f32 v44, v43
    v_sin_f32 v45, v43
    v_fmamk_f32 v46, v216, 0x40000000, v217
    v_cos_f32 v47, v46
    v_sin_f32 v48, v46
    v_fmamk_f32 v49, v216, 0x40400000, v217
    v_cos_f32 v50, v49
    v_sin_f32 v51, v49
    v_fmamk_f32 v217, v216, 0x41800000, v217
    s_set_gpr_idx_on s89, gpr_idx(DST)
    s_nop 1
    v_cvt_pk_bf16_f32 v184, v41, v42
    v_cvt_pk_bf16_f32 v185, v44, v45
    v_cvt_pk_bf16_f32 v186, v47, v48
    v_cvt_pk_bf16_f32 v187, v50, v51
    s_set_gpr_idx_off
    s_add_u32 s89, s89, 4
    s_cmp_lt_u32 s89, 8
    s_cbranch_scc1 L_gl_40
    s_nop 0
    s_cmp_eq_u32 s3, 0
    s_cbranch_scc0 L_fnw_41
    buffer_load_dword v236, v6, s[24:27], s48 offen sc1
    s_add_u32 s91, s48, 8192
    buffer_load_dword v237, v6, s[24:27], s91 offen sc1
    s_add_u32 s91, s48, 16384
    buffer_load_dword v238, v6, s[24:27], s91 offen sc1
    s_add_u32 s91, s48, 24576
    buffer_load_dword v239, v6, s[24:27], s91 offen sc1
    s_waitcnt vmcnt(0)
    s_mov_b32 s89, 0
    s_nop 0
L_fw_42:
    v_cmp_ne_u32 s[32:33], s88, v236
    v_cmp_ne_u32 s[34:35], s88, v237
    v_cmp_ne_u32 s[10:11], s88, v238
    v_cmp_ne_u32 s[96:97], s88, v239
    s_or_b64 vcc, s[32:33], s[34:35]
    s_or_b64 vcc, vcc, s[10:11]
    s_or_b64 vcc, vcc, s[96:97]
    s_cmp_eq_u64 vcc, 0
    s_cbranch_scc1 L_fd_43
    s_add_u32 s89, s89, 1
    s_cmp_gt_u32 s89, 40000
    s_cbranch_scc1 L_fd_43
    s_sleep 6
    s_add_u32 s91, s48, 0
    s_mov_b64 exec, s[32:33]
    s_cbranch_execz L_fk_44
    buffer_load_dword v236, v6, s[24:27], s91 offen sc1
L_fk_44:
    s_add_u32 s91, s48, 8192
    s_mov_b64 exec, s[34:35]
    s_cbranch_execz L_fk_45
    buffer_load_dword v237, v6, s[24:27], s91 offen sc1
L_fk_45:
    s_add_u32 s91, s48, 16384
    s_mov_b64 exec, s[10:11]
    s_cbranch_execz L_fk_46
    buffer_load_dword v238, v6, s[24:27], s91 offen sc1
L_fk_46:
    s_add_u32 s91, s48, 24576
    s_mov_b64 exec, s[96:97]
    s_cbranch_execz L_fk_47
    buffer_load_dword v239, v6, s[24:27], s91 offen sc1
L_fk_47:
    s_mov_b64 exec, -1
    s_waitcnt vmcnt(0)
    s_branch L_fw_42
    s_nop 0
L_fd_43:
L_fnw_41:
    s_waitcnt vmcnt(0)
    s_barrier
    buffer_load_dwordx4 v[40:43], v2, s[24:27], s40 offen offset:0 sc1
    buffer_load_dwordx4 v[44:47], v2, s[24:27], s40 offen offset:1024 sc1
    buffer_load_dwordx4 v[48:51], v2, s[24:27], s40 offen offset:2048 sc1
    buffer_load_dwordx4 v[52:55], v2, s[24:27], s40 offen offset:3072 sc1
    buffer_load_dwordx2 v[8:9], v232, s[24:27], s44 offen offset:0 sc1
    buffer_load_dwordx2 v[10:11], v232, s[24:27], s44 offen offset:512 sc1
    buffer_load_dwordx2 v[12:13], v232, s[24:27], s44 offen offset:1024 sc1
    buffer_load_dwordx2 v[14:15], v232, s[24:27], s44 offen offset:1536 sc1
    buffer_load_dwordx2 v[16:17], v232, s[24:27], s45 offen offset:0 sc1
    buffer_load_dwordx2 v[18:19], v232, s[24:27], s45 offen offset:512 sc1
    buffer_load_dwordx2 v[20:21], v232, s[24:27], s45 offen offset:1024 sc1
    buffer_load_dwordx2 v[22:23], v232, s[24:27], s45 offen offset:1536 sc1
    s_waitcnt vmcnt(11)
    ds_write_b128 v235, v[40:43] offset:16384
    s_waitcnt vmcnt(10)
    ds_write_b128 v235, v[44:47] offset:16896
    s_waitcnt vmcnt(9)
    ds_write_b128 v235, v[48:51] offset:17408
    s_waitcnt vmcnt(8)
    ds_write_b128 v235, v[52:55] offset:17920
    s_waitcnt lgkmcnt(0)
    s_barrier
    s_setprio 3
    ds_read_b128 v[40:43], v2 offset:16384
    ds_read_b128 v[56:59], v2 offset:20480
    ds_read_b128 v[44:47], v2 offset:17408
    ds_read_b128 v[60:63], v2 offset:21504
    ds_read_b128 v[48:51], v2 offset:18432
    ds_read_b128 v[64:67], v2 offset:22528
    ds_read_b128 v[52:55], v2 offset:19456
    ds_read_b128 v[68:71], v2 offset:23552
    ds_read_b128 v[88:91], v2 offset:24576
    ds_read_b128 v[104:107], v2 offset:28672
    ds_read_b128 v[92:95], v2 offset:25600
    ds_read_b128 v[108:111], v2 offset:29696
    ds_read_b128 v[96:99], v2 offset:26624
    ds_read_b128 v[112:115], v2 offset:30720
    ds_read_b128 v[100:103], v2 offset:27648
    ds_read_b128 v[116:119], v2 offset:31744
    s_waitcnt lgkmcnt(14)
    v_mfma_f32_16x16x32_bf16 v[72:75], v[40:43], v[128:131], 0
    v_mfma_f32_16x16x32_bf16 v[76:79], v[40:43], v[144:147], 0
    v_mfma_f32_16x16x32_bf16 v[80:83], v[56:59], v[128:131], 0
    v_mfma_f32_16x16x32_bf16 v[84:87], v[56:59], v[144:147], 0
    s_waitcnt lgkmcnt(12)
    v_mfma_f32_16x16x32_bf16 v[72:75], v[44:47], v[132:135], v[72:75]
    v_mfma_f32_16x16x32_bf16 v[76:79], v[44:47], v[148:151], v[76:79]
    v_mfma_f32_16x16x32_bf16 v[80:83], v[60:63], v[132:135], v[80:83]
    v_mfma_f32_16x16x32_bf16 v[84:87], v[60:63], v[148:151], v[84:87]
    s_waitcnt lgkmcnt(10)
    v_mfma_f32_16x16x32_bf16 v[72:75], v[48:51], v[136:139], v[72:75]
    v_mfma_f32_16x16x32_bf16 v[76:79], v[48:51], v[152:155], v[76:79]
    v_mfma_f32_16x16x32_bf16 v[80:83], v[64:67], v[136:139], v[80:83]
    v_mfma_f32_16x16x32_bf16 v[84:87], v[64:67], v[152:155], v[84:87]
    s_waitcnt lgkmcnt(8)
    v_mfma_f32_16x16x32_bf16 v[72:75], v[52:55], v[140:143], v[72:75]
    v_mfma_f32_16x16x32_bf16 v[76:79], v[52:55], v[156:159], v[76:79]
    v_mfma_f32_16x16x32_bf16 v[80:83], v[68:71], v[140:143], v[80:83]
    v_mfma_f32_16x16x32_bf16 v[84:87], v[68:71], v[156:159], v[84:87]
    s_waitcnt lgkmcnt(0)
    v_mfma_f32_16x16x32_bf16 v[192:195], v[88:91], v[128:131], 0
    v_mfma_f32_16x16x32_bf16 v[196:199], v[88:91], v[144:147], 0
    v_mfma_f32_16x16x32_bf16 v[200:203], v[104:107], v[128:131], 0
    v_mfma_f32_16x16x32_bf16 v[204:207], v[104:107], v[144:147], 0
    v_mul_f32 v216, v72, v24
    v_mul_f32 v217, v76, v24
    v_fmac_f32 v216, v76, v25
    v_fma_f32 v217, -v72, v25, v217
    v_mfma_f32_16x16x32_bf16 v[192:195], v[92:95], v[132:135], v[192:195]
    v_cvt_pk_bf16_f32 v120, v216, v217
    v_mul_f32 v218, v73, v26
    v_mul_f32 v219, v77, v26
    v_mfma_f32_16x16x32_bf16 v[196:199], v[92:95], v[148:151], v[196:199]
    v_fmac_f32 v218, v77, v27
    v_fma_f32 v219, -v73, v27, v219
    v_cvt_pk_bf16_f32 v121, v218, v219
    v_mfma_f32_16x16x32_bf16 v[200:203], v[108:111], v[132:135], v[200:203]
    v_mul_f32 v220, v74, v28
    v_mul_f32 v221, v78, v28
    v_fmac_f32 v220, v78, v29
    v_mfma_f32_16x16x32_bf16 v[204:207], v[108:111], v[148:151], v[204:207]
    v_fma_f32 v221, -v74, v29, v221
    v_cvt_pk_bf16_f32 v122, v220, v221
    v_mul_f32 v222, v75, v30
    v_mfma_f32_16x16x32_bf16 v[192:195], v[96:99], v[136:139], v[192:195]
    v_mul_f32 v223, v79, v30
    v_fmac_f32 v222, v79, v31
    v_fma_f32 v223, -v75, v31, v223
    v_mfma_f32_16x16x32_bf16 v[196:199], v[96:99], v[152:155], v[196:199]
    v_cvt_pk_bf16_f32 v123, v222, v223
    v_mul_f32 v216, v80, v32
    v_mul_f32 v217, v84, v32
    v_mfma_f32_16x16x32_bf16 v[200:203], v[112:115], v[136:139], v[200:203]
    v_fmac_f32 v216, v84, v33
    v_fma_f32 v217, -v80, v33, v217
    v_cvt_pk_bf16_f32 v124, v216, v217
    v_mfma_f32_16x16x32_bf16 v[204:207], v[112:115], v[152:155], v[204:207]
    v_mul_f32 v218, v81, v34
    v_mul_f32 v219, v85, v34
    v_fmac_f32 v218, v85, v35
    v_mfma_f32_16x16x32_bf16 v[192:195], v[100:103], v[140:143], v[192:195]
    v_fma_f32 v219, -v81, v35, v219
    v_cvt_pk_bf16_f32 v125, v218, v219
    v_mul_f32 v220, v82, v36
    v_mfma_f32_16x16x32_bf16 v[196:199], v[100:103], v[156:159], v[196:199]
    v_mul_f32 v221, v86, v36
    v_fmac_f32 v220, v86, v37
    v_fma_f32 v221, -v82, v37, v221
    v_mfma_f32_16x16x32_bf16 v[200:203], v[116:119], v[140:143], v[200:203]
    v_cvt_pk_bf16_f32 v126, v220, v221
    v_mul_f32 v222, v83, v38
    v_mul_f32 v223, v87, v38
    v_mfma_f32_16x16x32_bf16 v[204:207], v[116:119], v[156:159], v[204:207]
    v_fmac_f32 v222, v87, v39
    v_fma_f32 v223, -v83, v39, v223
    v_cvt_pk_bf16_f32 v127, v222, v223
    v_mfma_f32_16x16x32_bf16 v[72:75], v[160:163], v[120:123], 0
    v_mul_f32 v216, v192, v24
    v_mul_f32 v217, v196, v24
    v_fmac_f32 v216, v196, v25
    v_fma_f32 v217, -v192, v25, v217
    v_cvt_pk_bf16_f32 v208, v216, v217
    v_mfma_f32_16x16x32_bf16 v[76:79], v[168:171], v[120:123], 0
    v_mul_f32 v218, v193, v26
    v_mul_f32 v219, v197, v26
    v_fmac_f32 v218, v197, v27
    v_fma_f32 v219, -v193, v27, v219
    v_cvt_pk_bf16_f32 v209, v218, v219
    v_mfma_f32_16x16x32_bf16 v[80:83], v[176:179], v[120:123], 0
    v_mul_f32 v220, v194, v28
    v_mul_f32 v221, v198, v28
    v_fmac_f32 v220, v198, v29
    v_fma_f32 v221, -v194, v29, v221
    v_cvt_pk_bf16_f32 v210, v220, v221
    v_mfma_f32_16x16x32_bf16 v[84:87], v[184:187], v[120:123], 0
    v_mul_f32 v222, v195, v30
    v_mul_f32 v223, v199, v30
    v_fmac_f32 v222, v199, v31
    v_fma_f32 v223, -v195, v31, v223
    v_cvt_pk_bf16_f32 v211, v222, v223
    v_mfma_f32_16x16x32_bf16 v[72:75], v[164:167], v[124:127], v[72:75]
    v_mul_f32 v216, v200, v32
    v_mul_f32 v217, v204, v32
    v_fmac_f32 v216, v204, v33
    v_fma_f32 v217, -v200, v33, v217
    v_cvt_pk_bf16_f32 v212, v216, v217
    v_mfma_f32_16x16x32_bf16 v[76:79], v[172:175], v[124:127], v[76:79]
    v_mul_f32 v218, v201, v34
    v_mul_f32 v219, v205, v34
    v_fmac_f32 v218, v205, v35
    v_fma_f32 v219, -v201, v35, v219
    v_cvt_pk_bf16_f32 v213, v218, v219
    v_mfma_f32_16x16x32_bf16 v[80:83], v[180:183], v[124:127], v[80:83]
    v_mul_f32 v220, v202, v36
    v_mul_f32 v221, v206, v36
    v_fmac_f32 v220, v206, v37
    v_fma_f32 v221, -v202, v37, v221
    v_cvt_pk_bf16_f32 v214, v220, v221
    v_mfma_f32_16x16x32_bf16 v[84:87], v[188:191], v[124:127], v[84:87]
    v_mul_f32 v222, v203, v38
    v_mul_f32 v223, v207, v38
    v_fmac_f32 v222, v207, v39
    v_fma_f32 v223, -v203, v39, v223
    v_cvt_pk_bf16_f32 v215, v222, v223
    s_waitcnt vmcnt(0)
    v_mfma_f32_16x16x32_bf16 v[192:195], v[160:163], v[208:211], 0
    v_lshlrev_b32 v40, 16, v8
    v_and_b32 v41, 0xffff0000, v8
    v_lshlrev_b32 v42, 16, v10
    v_and_b32 v43, 0xffff0000, v10
    v_lshlrev_b32 v44, 16, v12
    v_and_b32 v45, 0xffff0000, v12
    v_lshlrev_b32 v46, 16, v14
    v_mfma_f32_16x16x32_bf16 v[196:199], v[168:171], v[208:211], 0
    v_and_b32 v47, 0xffff0000, v14
    v_lshlrev_b32 v48, 16, v16
    v_and_b32 v49, 0xffff0000, v16
    v_lshlrev_b32 v50, 16, v18
    v_and_b32 v51, 0xffff0000, v18
    v_lshlrev_b32 v52, 16, v20
    v_and_b32 v53, 0xffff0000, v20
    v_mfma_f32_16x16x32_bf16 v[200:203], v[176:179], v[208:211], 0
    v_lshlrev_b32 v54, 16, v22
    v_and_b32 v55, 0xffff0000, v22
    v_mul_f32 v216, v72, v40
    v_mul_f32 v217, v72, v41
    v_fma_f32 v216, -v73, v41, v216
    v_fmac_f32 v217, v73, v40
    v_cvt_pk_bf16_f32 v56, v216, -v217
    v_mfma_f32_16x16x32_bf16 v[204:207], v[184:187], v[208:211], 0
    v_mul_f32 v218, v74, v42
    v_mul_f32 v219, v74, v43
    v_fma_f32 v218, -v75, v43, v218
    v_fmac_f32 v219, v75, v42
    v_cvt_pk_bf16_f32 v57, v218, -v219
    v_mul_f32 v220, v76, v44
    v_mul_f32 v221, v76, v45
    v_mfma_f32_16x16x32_bf16 v[192:195], v[164:167], v[212:215], v[192:195]
    v_fma_f32 v220, -v77, v45, v220
    v_fmac_f32 v221, v77, v44
    v_cvt_pk_bf16_f32 v58, v220, -v221
    v_mul_f32 v222, v78, v46
    v_mul_f32 v223, v78, v47
    v_fma_f32 v222, -v79, v47, v222
    v_fmac_f32 v223, v79, v46
    v_mfma_f32_16x16x32_bf16 v[196:199], v[172:175], v[212:215], v[196:199]
    v_cvt_pk_bf16_f32 v59, v222, -v223
    v_mul_f32 v216, v80, v48
    v_mul_f32 v217, v80, v49
    v_fma_f32 v216, -v81, v49, v216
    v_fmac_f32 v217, v81, v48
    v_cvt_pk_bf16_f32 v60, v216, -v217
    v_mul_f32 v218, v82, v50
    v_mfma_f32_16x16x32_bf16 v[200:203], v[180:183], v[212:215], v[200:203]
    v_mul_f32 v219, v82, v51
    v_fma_f32 v218, -v83, v51, v218
    v_fmac_f32 v219, v83, v50
    v_cvt_pk_bf16_f32 v61, v218, -v219
    v_mul_f32 v220, v84, v52
    v_mul_f32 v221, v84, v53
    v_fma_f32 v220, -v85, v53, v220
    v_mfma_f32_16x16x32_bf16 v[204:207], v[188:191], v[212:215], v[204:207]
    v_fmac_f32 v221, v85, v52
    v_cvt_pk_bf16_f32 v62, v220, -v221
    v_mul_f32 v222, v86, v54
    v_mul_f32 v223, v86, v55
    v_fma_f32 v222, -v87, v55, v222
    v_fmac_f32 v223, v87, v54
    v_cvt_pk_bf16_f32 v63, v222, -v223
    v_mfma_f32_16x16x32_bf16 v[72:75], v[160:163], v[56:59], 0
    v_lshlrev_b32 v88, 16, v9
    v_and_b32 v89, 0xffff0000, v9
    v_lshlrev_b32 v90, 16, v11
    v_and_b32 v91, 0xffff0000, v11
    v_lshlrev_b32 v92, 16, v13
    v_and_b32 v93, 0xffff0000, v13
    v_lshlrev_b32 v94, 16, v15
    v_mfma_f32_16x16x32_bf16 v[76:79], v[168:171], v[56:59], 0
    v_and_b32 v95, 0xffff0000, v15
    v_lshlrev_b32 v96, 16, v17
    v_and_b32 v97, 0xffff0000, v17
    v_lshlrev_b32 v98, 16, v19
    v_and_b32 v99, 0xffff0000, v19
    v_lshlrev_b32 v100, 16, v21
    v_and_b32 v101, 0xffff0000, v21
    v_mfma_f32_16x16x32_bf16 v[80:83], v[176:179], v[56:59], 0
    v_lshlrev_b32 v102, 16, v23
    v_and_b32 v103, 0xffff0000, v23
    v_mul_f32 v216, v192, v88
    v_mul_f32 v217, v192, v89
    v_fma_f32 v216, -v193, v89, v216
    v_fmac_f32 v217, v193, v88
    v_cvt_pk_bf16_f32 v104, v216, -v217
    v_mfma_f32_16x16x32_bf16 v[84:87], v[184:187], v[56:59], 0
    v_mul_f32 v218, v194, v90
    v_mul_f32 v219, v194, v91
    v_fma_f32 v218, -v195, v91, v218
    v_fmac_f32 v219, v195, v90
    v_cvt_pk_bf16_f32 v105, v218, -v219
    v_mul_f32 v220, v196, v92
    v_mul_f32 v221, v196, v93
    v_mfma_f32_16x16x32_bf16 v[72:75], v[164:167], v[60:63], v[72:75]
    v_fma_f32 v220, -v197, v93, v220
    v_fmac_f32 v221, v197, v92
    v_cvt_pk_bf16_f32 v106, v220, -v221
    v_mul_f32 v222, v198, v94
    v_mul_f32 v223, v198, v95
    v_fma_f32 v222, -v199, v95, v222
    v_fmac_f32 v223, v199, v94
    v_mfma_f32_16x16x32_bf16 v[76:79], v[172:175], v[60:63], v[76:79]
    v_cvt_pk_bf16_f32 v107, v222, -v223
    v_mul_f32 v216, v200, v96
    v_mul_f32 v217, v200, v97
    v_fma_f32 v216, -v201, v97, v216
    v_fmac_f32 v217, v201, v96
    v_cvt_pk_bf16_f32 v108, v216, -v217
    v_mul_f32 v218, v202, v98
    v_mfma_f32_16x16x32_bf16 v[80:83], v[180:183], v[60:63], v[80:83]
    v_mul_f32 v219, v202, v99
    v_fma_f32 v218, -v203, v99, v218
    v_fmac_f32 v219, v203, v98
    v_cvt_pk_bf16_f32 v109, v218, -v219
    v_mul_f32 v220, v204, v100
    v_mul_f32 v221, v204, v101
    v_fma_f32 v220, -v205, v101, v220
    v_mfma_f32_16x16x32_bf16 v[84:87], v[188:191], v[60:63], v[84:87]
    v_fmac_f32 v221, v205, v100
    v_cvt_pk_bf16_f32 v110, v220, -v221
    v_mul_f32 v222, v206, v102
    v_mul_f32 v223, v206, v103
    v_fma_f32 v222, -v207, v103, v222
    v_fmac_f32 v223, v207, v102
    v_cvt_pk_bf16_f32 v111, v222, -v223
    v_mfma_f32_16x16x32_bf16 v[192:195], v[160:163], v[104:107], 0
    v_mul_f32 v216, v72, v24
    v_mul_f32 v217, v73, v24
    v_fmac_f32 v216, v73, v25
    v_fma_f32 v217, -v72, v25, v217
    v_cvt_pk_bf16_f32 v120, v216, v217
    ds_write_b32 v224, v120 offset:0
    v_mfma_f32_16x16x32_bf16 v[196:199], v[168:171], v[104:107], 0
    v_mul_f32 v218, v74, v26
    v_mul_f32 v219, v75, v26
    v_fmac_f32 v218, v75, v27
    v_fma_f32 v219, -v74, v27, v219
    v_cvt_pk_bf16_f32 v121, v218, v219
    ds_write_b32 v225, v121 offset:0
    v_mfma_f32_16x16x32_bf16 v[200:203], v[176:179], v[104:107], 0
    v_mul_f32 v220, v76, v28
    v_mul_f32 v221, v77, v28
    v_fmac_f32 v220, v77, v29
    v_fma_f32 v221, -v76, v29, v221
    v_cvt_pk_bf16_f32 v122, v220, v221
    ds_write_b32 v226, v122 offset:0
    v_mfma_f32_16x16x32_bf16 v[204:207], v[184:187], v[104:107], 0
    v_mul_f32 v222, v78, v30
    v_mul_f32 v223, v79, v30
    v_fmac_f32 v222, v79, v31
    v_fma_f32 v223, -v78, v31, v223
    v_cvt_pk_bf16_f32 v123, v222, v223
    ds_write_b32 v227, v123 offset:0
    v_mfma_f32_16x16x32_bf16 v[192:195], v[164:167], v[108:111], v[192:195]
    v_mul_f32 v216, v80, v32
    v_mul_f32 v217, v81, v32
    v_fmac_f32 v216, v81, v33
    v_fma_f32 v217, -v80, v33, v217
    v_cvt_pk_bf16_f32 v124, v216, v217
    ds_write_b32 v224, v124 offset:4096
    v_mfma_f32_16x16x32_bf16 v[196:199], v[172:175], v[108:111], v[196:199]
    v_mul_f32 v218, v82, v34
    v_mul_f32 v219, v83, v34
    v_fmac_f32 v218, v83, v35
    v_fma_f32 v219, -v82, v35, v219
    v_cvt_pk_bf16_f32 v125, v218, v219
    ds_write_b32 v225, v125 offset:4096
    v_mfma_f32_16x16x32_bf16 v[200:203], v[180:183], v[108:111], v[200:203]
    v_mul_f32 v220, v84, v36
    v_mul_f32 v221, v85, v36
    v_fmac_f32 v220, v85, v37
    v_fma_f32 v221, -v84, v37, v221
    v_cvt_pk_bf16_f32 v126, v220, v221
    ds_write_b32 v226, v126 offset:4096
    v_mfma_f32_16x16x32_bf16 v[204:207], v[188:191], v[108:111], v[204:207]
    v_mul_f32 v222, v86, v38
    v_mul_f32 v223, v87, v38
    v_fmac_f32 v222, v87, v39
    v_fma_f32 v223, -v86, v39, v223
    v_cvt_pk_bf16_f32 v127, v222, v223
    ds_write_b32 v227, v127 offset:4096
    v_mul_f32 v216, v192, v24
    v_mul_f32 v217, v193, v24
    v_fmac_f32 v216, v193, v25
    v_fma_f32 v217, -v192, v25, v217
    v_cvt_pk_bf16_f32 v208, v216, v217
    ds_write_b32 v224, v208 offset:8192
    v_mul_f32 v218, v194, v26
    v_mul_f32 v219, v195, v26
    v_fmac_f32 v218, v195, v27
    v_fma_f32 v219, -v194, v27, v219
    v_cvt_pk_bf16_f32 v209, v218, v219
    ds_write_b32 v225, v209 offset:8192
    v_mul_f32 v220, v196, v28
    v_mul_f32 v221, v197, v28
    v_fmac_f32 v220, v197, v29
    v_fma_f32 v221, -v196, v29, v221
    v_cvt_pk_bf16_f32 v210, v220, v221
    ds_write_b32 v226, v210 offset:8192
    v_mul_f32 v222, v198, v30
    v_mul_f32 v223, v199, v30
    v_fmac_f32 v222, v199, v31
    v_fma_f32 v223, -v198, v31, v223
    v_cvt_pk_bf16_f32 v211, v222, v223
    ds_write_b32 v227, v211 offset:8192
    v_mul_f32 v216, v200, v32
    v_mul_f32 v217, v201, v32
    v_fmac_f32 v216, v201, v33
    v_fma_f32 v217, -v200, v33, v217
    v_cvt_pk_bf16_f32 v212, v216, v217
    ds_write_b32 v224, v212 offset:12288
    v_mul_f32 v218, v202, v34
    v_mul_f32 v219, v203, v34
    v_fmac_f32 v218, v203, v35
    v_fma_f32 v219, -v202, v35, v219
    v_cvt_pk_bf16_f32 v213, v218, v219
    ds_write_b32 v225, v213 offset:12288
    v_mul_f32 v220, v204, v36
    v_mul_f32 v221, v205, v36
    v_fmac_f32 v220, v205, v37
    v_fma_f32 v221, -v204, v37, v221
    v_cvt_pk_bf16_f32 v214, v220, v221
    ds_write_b32 v226, v214 offset:12288
    v_mul_f32 v222, v206, v38
    v_mul_f32 v223, v207, v38
    v_fmac_f32 v222, v207, v39
    v_fma_f32 v223, -v206, v39, v223
    v_cvt_pk_bf16_f32 v215, v222, v223
    ds_write_b32 v227, v215 offset:12288
    s_waitcnt lgkmcnt(0)
    s_barrier
    ds_read_b128 v[40:43], v228 offset:0
    ds_read_b128 v[56:59], v228 offset:4096
    ds_read_b128 v[44:47], v229 offset:0
    ds_read_b128 v[60:63], v229 offset:4096
    ds_read_b128 v[48:51], v230 offset:0
    ds_read_b128 v[64:67], v230 offset:4096
    ds_read_b128 v[52:55], v231 offset:0
    ds_read_b128 v[68:71], v231 offset:4096
    ds_read_b128 v[88:91], v228 offset:8192
    ds_read_b128 v[104:107], v228 offset:12288
    ds_read_b128 v[92:95], v229 offset:8192
    ds_read_b128 v[108:111], v229 offset:12288
    ds_read_b128 v[96:99], v230 offset:8192
    ds_read_b128 v[112:115], v230 offset:12288
    ds_read_b128 v[100:103], v231 offset:8192
    ds_read_b128 v[116:119], v231 offset:12288
    s_waitcnt lgkmcnt(14)
    v_mfma_f32_16x16x32_bf16 v[72:75], v[128:131], v[40:43], 0
    v_mfma_f32_16x16x32_bf16 v[76:79], v[144:147], v[40:43], 0
    v_mfma_f32_16x16x32_bf16 v[80:83], v[128:131], v[56:59], 0
    v_mfma_f32_16x16x32_bf16 v[84:87], v[144:147], v[56:59], 0
    s_waitcnt lgkmcnt(12)
    v_mfma_f32_16x16x32_bf16 v[72:75], v[132:135], v[44:47], v[72:75]
    v_mfma_f32_16x16x32_bf16 v[76:79], v[148:151], v[44:47], v[76:79]
    v_mfma_f32_16x16x32_bf16 v[80:83], v[132:135], v[60:63], v[80:83]
    v_mfma_f32_16x16x32_bf16 v[84:87], v[148:151], v[60:63], v[84:87]
    s_waitcnt lgkmcnt(10)
    v_mfma_f32_16x16x32_bf16 v[72:75], v[136:139], v[48:51], v[72:75]
    v_mfma_f32_16x16x32_bf16 v[76:79], v[152:155], v[48:51], v[76:79]
    v_mfma_f32_16x16x32_bf16 v[80:83], v[136:139], v[64:67], v[80:83]
    v_mfma_f32_16x16x32_bf16 v[84:87], v[152:155], v[64:67], v[84:87]
    s_waitcnt lgkmcnt(8)
    v_mfma_f32_16x16x32_bf16 v[72:75], v[140:143], v[52:55], v[72:75]
    v_mfma_f32_16x16x32_bf16 v[76:79], v[156:159], v[52:55], v[76:79]
    v_mfma_f32_16x16x32_bf16 v[80:83], v[140:143], v[68:71], v[80:83]
    v_mfma_f32_16x16x32_bf16 v[84:87], v[156:159], v[68:71], v[84:87]
    s_waitcnt lgkmcnt(0)
    v_mfma_f32_16x16x32_bf16 v[192:195], v[128:131], v[88:91], 0
    v_mfma_f32_16x16x32_bf16 v[196:199], v[144:147], v[88:91], 0
    v_mfma_f32_16x16x32_bf16 v[200:203], v[128:131], v[104:107], 0
    v_mfma_f32_16x16x32_bf16 v[204:207], v[144:147], v[104:107], 0
    s_nop 0
    v_cvt_pk_bf16_f32 v120, v72, -v76
    v_mfma_f32_16x16x32_bf16 v[192:195], v[132:135], v[92:95], v[192:195]
    v_cvt_pk_bf16_f32 v121, v73, -v77
    v_mfma_f32_16x16x32_bf16 v[196:199], v[148:151], v[92:95], v[196:199]
    v_mfma_f32_16x16x32_bf16 v[200:203], v[132:135], v[108:111], v[200:203]
    v_cvt_pk_bf16_f32 v122, v74, -v78
    v_mfma_f32_16x16x32_bf16 v[204:207], v[148:151], v[108:111], v[204:207]
    v_cvt_pk_bf16_f32 v123, v75, -v79
    v_mfma_f32_16x16x32_bf16 v[192:195], v[136:139], v[96:99], v[192:195]
    v_mfma_f32_16x16x32_bf16 v[196:199], v[152:155], v[96:99], v[196:199]
    v_cvt_pk_bf16_f32 v124, v80, -v84
    v_mfma_f32_16x16x32_bf16 v[200:203], v[136:139], v[112:115], v[200:203]
    v_mfma_f32_16x16x32_bf16 v[204:207], v[152:155], v[112:115], v[204:207]
    v_cvt_pk_bf16_f32 v125, v81, -v85
    v_mfma_f32_16x16x32_bf16 v[192:195], v[140:143], v[100:103], v[192:195]
    v_cvt_pk_bf16_f32 v126, v82, -v86
    v_mfma_f32_16x16x32_bf16 v[196:199], v[156:159], v[100:103], v[196:199]
    v_mfma_f32_16x16x32_bf16 v[200:203], v[140:143], v[116:119], v[200:203]
    v_cvt_pk_bf16_f32 v127, v83, -v87
    v_mfma_f32_16x16x32_bf16 v[204:207], v[156:159], v[116:119], v[204:207]
    s_nop 4
    v_cvt_pk_bf16_f32 v208, v192, -v196
    v_cvt_pk_bf16_f32 v209, v193, -v197
    v_cvt_pk_bf16_f32 v210, v194, -v198
    v_cvt_pk_bf16_f32 v211, v195, -v199
    v_permlane32_swap_b32 v120, v208
    v_permlane32_swap_b32 v121, v209
    v_permlane32_swap_b32 v122, v210
    v_permlane32_swap_b32 v123, v211
    buffer_store_dwordx4 v[120:123], v234, s[24:27], s46 offen offset:0 sc1
    buffer_store_dwordx4 v[208:211], v234, s[24:27], s46 offen offset:1024 sc1
    v_cvt_pk_bf16_f32 v212, v200, -v204
    v_cvt_pk_bf16_f32 v213, v201, -v205
    v_cvt_pk_bf16_f32 v214, v202, -v206
    v_cvt_pk_bf16_f32 v215, v203, -v207
    v_permlane32_swap_b32 v124, v212
    v_permlane32_swap_b32 v125, v213
    v_permlane32_swap_b32 v126, v214
    v_permlane32_swap_b32 v127, v215
    buffer_store_dwordx4 v[124:127], v234, s[24:27], s47 offen offset:0 sc1
    buffer_store_dwordx4 v[212:215], v234, s[24:27], s47 offen offset:1024 sc1
    s_lshl_b32 s78, s2, 7
    s_add_u32 s78, s78, 19144704
    s_lshl_b32 s79, s2, 7
    s_add_u32 s79, s79, 19177472
    s_cmp_lt_u32 s2, 95
    s_cselect_b32 s79, s79, 1073741824
    s_waitcnt vmcnt(0)
    s_barrier
    s_cmp_eq_u32 s3, 0
    s_cbranch_scc0 L_pb_48
    v_mov_b32 v216, s88
    s_mov_b64 exec, 1
    buffer_store_dword v216, v5, s[24:27], s78 offen sc0 sc1
    buffer_store_dword v216, v5, s[24:27], s79 offen sc0 sc1
    s_mov_b64 exec, -1
    s_nop 0
L_pb_48:
L_fskip_33:
    s_setprio 3
    s_lshr_b32 s40, s2, 3
    s_and_b32 s91, s2, 1
    s_lshl_b32 s91, s91, 6
    s_add_u32 s40, s40, s91
    s_and_b32 s91, s2, 2
    s_lshl_b32 s91, s91, 4
    s_add_u32 s40, s40, s91
    s_and_b32 s91, s2, 4
    s_lshl_b32 s91, s91, 5
    s_add_u32 s40, s40, s91
    s_bfe_u32 s41, s40, 0x40003
    s_lshl_b32 s41, s41, 7
    s_lshr_b32 s43, s40, 7
    s_lshl_b32 s43, s43, 4
    s_add_u32 s41, s41, s43
    s_and_b32 s43, s40, 7
    s_lshl_b32 s43, s43, 1
    s_add_u32 s41, s41, s43
    s_and_b32 s42, s3, 1
    s_lshr_b32 s44, s3, 1
    v_lshrrev_b32 v107, 1, v0
    v_and_b32 v112, 1, v0
    v_lshlrev_b32 v112, 5, v112
    v_lshrrev_b32 v110, 1, v107
    v_mul_u32_u24 v108, 16512, v110
    v_and_b32 v110, 1, v107
    v_lshl_add_u32 v112, v110, 4, v112
    v_add_u32 v108, v108, v112
    v_sub_u32 v111, 80, v107
    v_lshrrev_b32 v111, 1, v111
    v_and_b32 v111, 63, v111
    v_mul_u32_u24 v109, 16512, v111
    v_add_u32 v109, v109, v112
    v_mov_b32 v111, 1073741824
    v_cmp_ge_u32 vcc, 80, v107
    s_nop 1
    v_cndmask_b32 v108, v111, v108, vcc
    v_cndmask_b32 v109, v111, v109, vcc
    s_lshl_b32 s70, s40, 6
    s_add_u32 s70, s70, 13582336
    s_add_u32 s71, s70, 1320960
    s_add_u32 s72, s70, 1981440
    s_add_u32 s73, s70, 660480
    s_mul_i32 s41, s41, 1280
    s_lshl_b32 s47, s3, 8
    s_add_u32 s50, s41, s47
    s_lshl_b32 s47, s44, 7
    s_add_u32 s51, s41, s47
    s_mul_i32 s47, s42, 1280
    s_add_u32 s51, s51, s47
    s_add_u32 s51, s51, 1024
    s_add_u32 s52, s50, 16244736
    s_add_u32 s53, s51, 16244736
    v_mul_u32_u24 v113, 40960, v4
    v_lshl_add_u32 v113, v3, 3, v113
    buffer_load_dwordx2 v[96:97], v113, s[28:31], s50 offen offset:0
    buffer_load_dwordx2 v[98:99], v113, s[28:31], s50 offen offset:1280
    buffer_load_dwordx2 v[100:101], v113, s[28:31], s50 offen offset:128
    buffer_load_dwordx2 v[102:103], v113, s[28:31], s50 offen offset:1408
    buffer_load_dwordx2 v[104:105], v113, s[28:31], s51 offen offset:0
    v_cvt_f32_u32 v110, v107
    v_mul_f32 v111, 0x3acccccd, v110
    v_cos_f32 v115, v111
    v_sin_f32 v116, v111
    v_mul_f32 v111, 0x3b4ccccd, v110
    v_cos_f32 v117, v111
    v_sin_f32 v118, v111
    v_mul_f32 v111, 0x3b99999a, v110
    v_cos_f32 v119, v111
    v_sin_f32 v120, v111
    v_mov_b32 v114, 0x35cccccd
    v_mov_b32 v110, 0x354ccccd
    v_cmp_eq_u32 vcc, 0, v107
    s_nop 1
    v_cndmask_b32 v114, v114, v110, vcc
    v_cmp_eq_u32 vcc, 80, v107
    s_nop 1
    v_cndmask_b32 v114, v114, v110, vcc
    v_mul_f32 v115, v115, v114
    v_mul_f32 v116, v116, v114
    v_mul_f32 v117, v117, v114
    v_mul_f32 v118, v118, v114
    v_mul_f32 v119, v119, v114
    v_mul_f32 v120, v120, v114
    v_cvt_f32_u32 v112, v4
    v_mul_f32 v112, 4.0, v112
    s_lshl_b32 s45, s3, 5
    s_add_u32 s46, s45, 16
    s_lshl_b32 s47, s44, 4
    s_add_u32 s47, s47, 128
    v_add_u32 v110, s45, v3
    v_cvt_f32_u32 v110, v110
    v_mul_f32 v110, 0x3bcccccd, v110
    v_mul_f32 v111, v112, v110
    s_mov_b32 s89, 0
    s_nop 0
L_gl_49:
    v_fmamk_f32 v136, v110, 0x00000000, v111
    v_cos_f32 v137, v136
    v_sin_f32 v138, v136
    v_fmamk_f32 v139, v110, 0x3f800000, v111
    v_cos_f32 v140, v139
    v_sin_f32 v141, v139
    v_fmamk_f32 v142, v110, 0x40000000, v111
    v_cos_f32 v143, v142
    v_sin_f32 v144, v142
    v_fmamk_f32 v145, v110, 0x40400000, v111
    v_cos_f32 v146, v145
    v_sin_f32 v147, v145
    v_fmamk_f32 v111, v110, 0x41800000, v111
    s_set_gpr_idx_on s89, gpr_idx(DST)
    s_nop 1
    v_cvt_pk_bf16_f32 v24, v137, -v138
    v_cvt_pk_bf16_f32 v25, v140, -v141
    v_cvt_pk_bf16_f32 v26, v143, -v144
    v_cvt_pk_bf16_f32 v27, v146, -v147
    s_set_gpr_idx_off
    s_add_u32 s89, s89, 4
    s_cmp_lt_u32 s89, 24
    s_cbranch_scc1 L_gl_49
    s_nop 0
    v_add_u32 v110, s46, v3
    v_cvt_f32_u32 v110, v110
    v_mul_f32 v110, 0x3bcccccd, v110
    v_mul_f32 v111, v112, v110
    s_mov_b32 s89, 0
    s_nop 0
L_gl_50:
    v_fmamk_f32 v136, v110, 0x00000000, v111
    v_cos_f32 v137, v136
    v_sin_f32 v138, v136
    v_fmamk_f32 v139, v110, 0x3f800000, v111
    v_cos_f32 v140, v139
    v_sin_f32 v141, v139
    v_fmamk_f32 v142, v110, 0x40000000, v111
    v_cos_f32 v143, v142
    v_sin_f32 v144, v142
    v_fmamk_f32 v145, v110, 0x40400000, v111
    v_cos_f32 v146, v145
    v_sin_f32 v147, v145
    v_fmamk_f32 v111, v110, 0x41800000, v111
    s_set_gpr_idx_on s89, gpr_idx(DST)
    s_nop 1
    v_cvt_pk_bf16_f32 v48, v137, -v138
    v_cvt_pk_bf16_f32 v49, v140, -v141
    v_cvt_pk_bf16_f32 v50, v143, -v144
    v_cvt_pk_bf16_f32 v51, v146, -v147
    s_set_gpr_idx_off
    s_add_u32 s89, s89, 4
    s_cmp_lt_u32 s89, 24
    s_cbranch_scc1 L_gl_50
    s_nop 0
    v_add_u32 v110, s47, v3
    v_cvt_f32_u32 v110, v110
    v_mul_f32 v110, 0x3bcccccd, v110
    v_mul_f32 v111, v112, v110
    s_mov_b32 s89, 0
    s_nop 0
L_gl_51:
    v_fmamk_f32 v136, v110, 0x00000000, v111
    v_cos_f32 v137, v136
    v_sin_f32 v138, v136
    v_fmamk_f32 v139, v110, 0x3f800000, v111
    v_cos_f32 v140, v139
    v_sin_f32 v141, v139
    v_fmamk_f32 v142, v110, 0x40000000, v111
    v_cos_f32 v143, v142
    v_sin_f32 v144, v142
    v_fmamk_f32 v145, v110, 0x40400000, v111
    v_cos_f32 v146, v145
    v_sin_f32 v147, v145
    v_fmamk_f32 v111, v110, 0x41800000, v111
    s_set_gpr_idx_on s89, gpr_idx(DST)
    s_nop 1
    v_cvt_pk_bf16_f32 v72, v137, -v138
    v_cvt_pk_bf16_f32 v73, v140, -v141
    v_cvt_pk_bf16_f32 v74, v143, -v144
    v_cvt_pk_bf16_f32 v75, v146, -v147
    s_set_gpr_idx_off
    s_add_u32 s89, s89, 4
    s_cmp_lt_u32 s89, 24
    s_cbranch_scc1 L_gl_51
    s_nop 0
    v_lshrrev_b32 v110, 2, v107
    v_lshlrev_b32 v133, 4, v110
    v_and_b32 v110, 3, v107
    v_lshl_add_u32 v133, v110, 2, v133
    v_and_b32 v110, 1, v0
    v_lshl_add_u32 v133, v110, 13, v133
    s_lshl_b32 s55, s42, 13
    v_lshlrev_b32 v111, 9, v3
    v_add_u32 v111, 16384, v111
    v_add_u32 v110, 0, v4
    v_xor_b32 v110, v110, v3
    v_lshl_add_u32 v121, v110, 4, v111
    v_add_u32 v110, 4, v4
    v_xor_b32 v110, v110, v3
    v_lshl_add_u32 v122, v110, 4, v111
    v_add_u32 v110, 8, v4
    v_xor_b32 v110, v110, v3
    v_lshl_add_u32 v123, v110, 4, v111
    v_add_u32 v110, 12, v4
    v_xor_b32 v110, v110, v3
    v_lshl_add_u32 v124, v110, 4, v111
    v_add_u32 v110, 16, v4
    v_xor_b32 v110, v110, v3
    v_lshl_add_u32 v125, v110, 4, v111
    v_add_u32 v110, 20, v4
    v_xor_b32 v110, v110, v3
    v_lshl_add_u32 v126, v110, 4, v111
    v_add_u32 v127, s55, v121
    v_add_u32 v128, s55, v122
    v_add_u32 v129, s55, v123
    v_add_u32 v130, s55, v124
    v_add_u32 v131, s55, v125
    v_add_u32 v132, s55, v126
    s_cmp_eq_u32 s3, 0
    s_cbranch_scc0 L_iw_52
    s_cmp_lt_u32 s2, 161
    s_cbranch_scc1 L_inf_53
    s_lshl_b32 s48, s2, 7
    s_add_u32 s48, s48, 19156864
    buffer_load_dword v8, v5, s[24:27], s48 offen sc1
    s_waitcnt vmcnt(0)
    s_mov_b32 s89, 0
    s_nop 0
L_fw_54:
    v_cmp_ne_u32 vcc, s88, v8
    s_nop 1
    s_cmp_eq_u64 vcc, 0
    s_cbranch_scc1 L_fd_55
    s_add_u32 s89, s89, 1
    s_cmp_gt_u32 s89, 20000
    s_cbranch_scc1 L_fd_55
    s_sleep 12
    buffer_load_dword v8, v5, s[24:27], s48 offen sc1
    s_waitcnt vmcnt(0)
    s_branch L_fw_54
    s_nop 0
L_fd_55:
L_inf_53:
    s_mov_b32 s48, 19144704
    v_min_u32 v110, 4096, v6
    buffer_load_dword v8, v6, s[24:27], s48 offen sc1
    s_add_u32 s91, s48, 8192
    buffer_load_dword v9, v6, s[24:27], s91 offen sc1
    s_add_u32 s91, s48, 16384
    buffer_load_dword v10, v110, s[24:27], s91 offen sc1
    s_waitcnt vmcnt(0)
    s_mov_b32 s89, 0
    s_nop 0
L_fw_56:
    v_cmp_ne_u32 s[32:33], s88, v8
    v_cmp_ne_u32 s[34:35], s88, v9
    v_cmp_ne_u32 s[10:11], s88, v10
    s_nop 0
    s_or_b64 vcc, s[32:33], s[34:35]
    s_or_b64 vcc, vcc, s[10:11]
    s_cmp_eq_u64 vcc, 0
    s_cbranch_scc1 L_fd_57
    s_add_u32 s89, s89, 1
    s_cmp_gt_u32 s89, 40000
    s_cbranch_scc1 L_fd_57
    s_sleep 6
    s_add_u32 s91, s48, 0
    s_mov_b64 exec, s[32:33]
    s_cbranch_execz L_fk_58
    buffer_load_dword v8, v6, s[24:27], s91 offen sc1
L_fk_58:
    s_add_u32 s91, s48, 8192
    s_mov_b64 exec, s[34:35]
    s_cbranch_execz L_fk_59
    buffer_load_dword v9, v6, s[24:27], s91 offen sc1
L_fk_59:
    s_add_u32 s91, s48, 16384
    s_mov_b64 exec, s[10:11]
    s_cbranch_execz L_fk_60
    buffer_load_dword v10, v110, s[24:27], s91 offen sc1
L_fk_60:
    s_mov_b64 exec, -1
    s_waitcnt vmcnt(0)
    s_branch L_fw_56
    s_nop 0
L_fd_57:
L_iw_52:
    s_barrier
    s_setprio 3
    buffer_load_dwordx4 v[8:11], v108, s[24:27], s70 offen sc1
    buffer_load_dwordx4 v[12:15], v108, s[24:27], s71 offen sc1
    buffer_load_dwordx4 v[16:19], v109, s[24:27], s72 offen sc1
    buffer_load_dwordx4 v[20:23], v109, s[24:27], s73 offen sc1
    s_waitcnt vmcnt(0)
    v_lshlrev_b32 v136, 16, v8
    v_and_b32 v137, 0xffff0000, v8
    v_lshlrev_b32 v138, 16, v12
    v_and_b32 v139, 0xffff0000, v12
    v_lshlrev_b32 v140, 16, v16
    v_and_b32 v141, 0xffff0000, v16
    v_lshlrev_b32 v142, 16, v20
    v_and_b32 v143, 0xffff0000, v20
    v_add_f32 v144, v136, v140
    v_sub_f32 v145, v137, v141
    v_sub_f32 v146, v136, v140
    v_add_f32 v147, v137, v141
    v_add_f32 v148, v138, v142
    v_sub_f32 v149, v139, v143
    v_sub_f32 v150, v138, v142
    v_add_f32 v151, v139, v143
    v_add_f32 v136, v144, v148
    v_add_f32 v137, v145, v149
    v_sub_f32 v138, v146, v151
    v_add_f32 v139, v147, v150
    v_sub_f32 v140, v144, v148
    v_sub_f32 v141, v145, v149
    v_add_f32 v142, v146, v151
    v_sub_f32 v143, v147, v150
    v_mul_f32 v136, v136, v114
    v_mul_f32 v137, v137, v114
    v_cvt_pk_bf16_f32 v152, v136, v137
    v_mul_f32 v146, v138, v115
    v_mul_f32 v147, v139, v115
    v_fma_f32 v146, -v139, v116, v146
    v_fmac_f32 v147, v138, v116
    v_cvt_pk_bf16_f32 v153, v146, v147
    v_mul_f32 v148, v140, v117
    v_mul_f32 v149, v141, v117
    v_fma_f32 v148, -v141, v118, v148
    v_fmac_f32 v149, v140, v118
    v_cvt_pk_bf16_f32 v154, v148, v149
    v_mul_f32 v150, v142, v119
    v_mul_f32 v151, v143, v119
    v_fma_f32 v150, -v143, v120, v150
    v_fmac_f32 v151, v142, v120
    v_cvt_pk_bf16_f32 v155, v150, v151
    v_xor_b32 v156, 0, v133
    ds_write_b32 v156, v152 offset:16384
    v_xor_b32 v157, 16, v133
    ds_write_b32 v157, v153 offset:16896
    v_xor_b32 v158, 32, v133
    ds_write_b32 v158, v154 offset:17408
    v_xor_b32 v159, 48, v133
    ds_write_b32 v159, v155 offset:17920
    v_lshlrev_b32 v136, 16, v9
    v_and_b32 v137, 0xffff0000, v9
    v_lshlrev_b32 v138, 16, v13
    v_and_b32 v139, 0xffff0000, v13
    v_lshlrev_b32 v140, 16, v17
    v_and_b32 v141, 0xffff0000, v17
    v_lshlrev_b32 v142, 16, v21
    v_and_b32 v143, 0xffff0000, v21
    v_add_f32 v144, v136, v140
    v_sub_f32 v145, v137, v141
    v_sub_f32 v146, v136, v140
    v_add_f32 v147, v137, v141
    v_add_f32 v148, v138, v142
    v_sub_f32 v149, v139, v143
    v_sub_f32 v150, v138, v142
    v_add_f32 v151, v139, v143
    v_add_f32 v136, v144, v148
    v_add_f32 v137, v145, v149
    v_sub_f32 v138, v146, v151
    v_add_f32 v139, v147, v150
    v_sub_f32 v140, v144, v148
    v_sub_f32 v141, v145, v149
    v_add_f32 v142, v146, v151
    v_sub_f32 v143, v147, v150
    v_mul_f32 v136, v136, v114
    v_mul_f32 v137, v137, v114
    v_cvt_pk_bf16_f32 v152, v136, v137
    v_mul_f32 v146, v138, v115
    v_mul_f32 v147, v139, v115
    v_fma_f32 v146, -v139, v116, v146
    v_fmac_f32 v147, v138, v116
    v_cvt_pk_bf16_f32 v153, v146, v147
    v_mul_f32 v148, v140, v117
    v_mul_f32 v149, v141, v117
    v_fma_f32 v148, -v141, v118, v148
    v_fmac_f32 v149, v140, v118
    v_cvt_pk_bf16_f32 v154, v148, v149
    v_mul_f32 v150, v142, v119
    v_mul_f32 v151, v143, v119
    v_fma_f32 v150, -v143, v120, v150
    v_fmac_f32 v151, v142, v120
    v_cvt_pk_bf16_f32 v155, v150, v151
    v_xor_b32 v156, 64, v133
    ds_write_b32 v156, v152 offset:18432
    v_xor_b32 v157, 80, v133
    ds_write_b32 v157, v153 offset:18944
    v_xor_b32 v158, 96, v133
    ds_write_b32 v158, v154 offset:19456
    v_xor_b32 v159, 112, v133
    ds_write_b32 v159, v155 offset:19968
    v_lshlrev_b32 v136, 16, v10
    v_and_b32 v137, 0xffff0000, v10
    v_lshlrev_b32 v138, 16, v14
    v_and_b32 v139, 0xffff0000, v14
    v_lshlrev_b32 v140, 16, v18
    v_and_b32 v141, 0xffff0000, v18
    v_lshlrev_b32 v142, 16, v22
    v_and_b32 v143, 0xffff0000, v22
    v_add_f32 v144, v136, v140
    v_sub_f32 v145, v137, v141
    v_sub_f32 v146, v136, v140
    v_add_f32 v147, v137, v141
    v_add_f32 v148, v138, v142
    v_sub_f32 v149, v139, v143
    v_sub_f32 v150, v138, v142
    v_add_f32 v151, v139, v143
    v_add_f32 v136, v144, v148
    v_add_f32 v137, v145, v149
    v_sub_f32 v138, v146, v151
    v_add_f32 v139, v147, v150
    v_sub_f32 v140, v144, v148
    v_sub_f32 v141, v145, v149
    v_add_f32 v142, v146, v151
    v_sub_f32 v143, v147, v150
    v_mul_f32 v136, v136, v114
    v_mul_f32 v137, v137, v114
    v_cvt_pk_bf16_f32 v152, v136, v137
    v_mul_f32 v146, v138, v115
    v_mul_f32 v147, v139, v115
    v_fma_f32 v146, -v139, v116, v146
    v_fmac_f32 v147, v138, v116
    v_cvt_pk_bf16_f32 v153, v146, v147
    v_mul_f32 v148, v140, v117
    v_mul_f32 v149, v141, v117
    v_fma_f32 v148, -v141, v118, v148
    v_fmac_f32 v149, v140, v118
    v_cvt_pk_bf16_f32 v154, v148, v149
    v_mul_f32 v150, v142, v119
    v_mul_f32 v151, v143, v119
    v_fma_f32 v150, -v143, v120, v150
    v_fmac_f32 v151, v142, v120
    v_cvt_pk_bf16_f32 v155, v150, v151
    v_xor_b32 v156, 128, v133
    ds_write_b32 v156, v152 offset:20480
    v_xor_b32 v157, 144, v133
    ds_write_b32 v157, v153 offset:20992
    v_xor_b32 v158, 160, v133
    ds_write_b32 v158, v154 offset:21504
    v_xor_b32 v159, 176, v133
    ds_write_b32 v159, v155 offset:22016
    v_lshlrev_b32 v136, 16, v11
    v_and_b32 v137, 0xffff0000, v11
    v_lshlrev_b32 v138, 16, v15
    v_and_b32 v139, 0xffff0000, v15
    v_lshlrev_b32 v140, 16, v19
    v_and_b32 v141, 0xffff0000, v19
    v_lshlrev_b32 v142, 16, v23
    v_and_b32 v143, 0xffff0000, v23
    v_add_f32 v144, v136, v140
    v_sub_f32 v145, v137, v141
    v_sub_f32 v146, v136, v140
    v_add_f32 v147, v137, v141
    v_add_f32 v148, v138, v142
    v_sub_f32 v149, v139, v143
    v_sub_f32 v150, v138, v142
    v_add_f32 v151, v139, v143
    v_add_f32 v136, v144, v148
    v_add_f32 v137, v145, v149
    v_sub_f32 v138, v146, v151
    v_add_f32 v139, v147, v150
    v_sub_f32 v140, v144, v148
    v_sub_f32 v141, v145, v149
    v_add_f32 v142, v146, v151
    v_sub_f32 v143, v147, v150
    v_mul_f32 v136, v136, v114
    v_mul_f32 v137, v137, v114
    v_cvt_pk_bf16_f32 v152, v136, v137
    v_mul_f32 v146, v138, v115
    v_mul_f32 v147, v139, v115
    v_fma_f32 v146, -v139, v116, v146
    v_fmac_f32 v147, v138, v116
    v_cvt_pk_bf16_f32 v153, v146, v147
    v_mul_f32 v148, v140, v117
    v_mul_f32 v149, v141, v117
    v_fma_f32 v148, -v141, v118, v148
    v_fmac_f32 v149, v140, v118
    v_cvt_pk_bf16_f32 v154, v148, v149
    v_mul_f32 v150, v142, v119
    v_mul_f32 v151, v143, v119
    v_fma_f32 v150, -v143, v120, v150
    v_fmac_f32 v151, v142, v120
    v_cvt_pk_bf16_f32 v155, v150, v151
    v_xor_b32 v156, 192, v133
    ds_write_b32 v156, v152 offset:22528
    v_xor_b32 v157, 208, v133
    ds_write_b32 v157, v153 offset:23040
    v_xor_b32 v158, 224, v133
    ds_write_b32 v158, v154 offset:23552
    v_xor_b32 v159, 240, v133
    ds_write_b32 v159, v155 offset:24064
    s_waitcnt lgkmcnt(0)
    s_barrier
    ds_read_b128 v[160:163], v121
    ds_read_b128 v[184:187], v121 offset:8192
    ds_read_b128 v[164:167], v122
    ds_read_b128 v[188:191], v122 offset:8192
    ds_read_b128 v[168:171], v123
    ds_read_b128 v[192:195], v123 offset:8192
    ds_read_b128 v[172:175], v124
    ds_read_b128 v[196:199], v124 offset:8192
    ds_read_b128 v[176:179], v125
    ds_read_b128 v[200:203], v125 offset:8192
    ds_read_b128 v[180:183], v126
    ds_read_b128 v[204:207], v126 offset:8192
    ds_read_b128 v[208:211], v127
    ds_read_b128 v[212:215], v128
    ds_read_b128 v[216:219], v129
    ds_read_b128 v[220:223], v130
    ds_read_b128 v[224:227], v131
    ds_read_b128 v[228:231], v132
    s_waitcnt lgkmcnt(0)
    v_mfma_f32_16x16x32_bf16 v[136:139], v[160:163], v[24:27], 0
    v_mfma_f32_16x16x32_bf16 v[140:143], v[184:187], v[24:27], 0
    v_mfma_f32_16x16x32_bf16 v[144:147], v[160:163], v[48:51], 0
    v_mfma_f32_16x16x32_bf16 v[148:151], v[184:187], v[48:51], 0
    v_mfma_f32_16x16x32_bf16 v[152:155], v[208:211], v[72:75], 0
    v_mfma_f32_16x16x32_bf16 v[136:139], v[164:167], v[28:31], v[136:139]
    v_mfma_f32_16x16x32_bf16 v[140:143], v[188:191], v[28:31], v[140:143]
    v_mfma_f32_16x16x32_bf16 v[144:147], v[164:167], v[52:55], v[144:147]
    v_mfma_f32_16x16x32_bf16 v[148:151], v[188:191], v[52:55], v[148:151]
    v_mfma_f32_16x16x32_bf16 v[152:155], v[212:215], v[76:79], v[152:155]
    v_mfma_f32_16x16x32_bf16 v[136:139], v[168:171], v[32:35], v[136:139]
    v_mfma_f32_16x16x32_bf16 v[140:143], v[192:195], v[32:35], v[140:143]
    v_mfma_f32_16x16x32_bf16 v[144:147], v[168:171], v[56:59], v[144:147]
    v_mfma_f32_16x16x32_bf16 v[148:151], v[192:195], v[56:59], v[148:151]
    v_mfma_f32_16x16x32_bf16 v[152:155], v[216:219], v[80:83], v[152:155]
    v_mfma_f32_16x16x32_bf16 v[136:139], v[172:175], v[36:39], v[136:139]
    v_mfma_f32_16x16x32_bf16 v[140:143], v[196:199], v[36:39], v[140:143]
    v_mfma_f32_16x16x32_bf16 v[144:147], v[172:175], v[60:63], v[144:147]
    v_mfma_f32_16x16x32_bf16 v[148:151], v[196:199], v[60:63], v[148:151]
    v_mfma_f32_16x16x32_bf16 v[152:155], v[220:223], v[84:87], v[152:155]
    v_mfma_f32_16x16x32_bf16 v[136:139], v[176:179], v[40:43], v[136:139]
    v_mfma_f32_16x16x32_bf16 v[140:143], v[200:203], v[40:43], v[140:143]
    v_mfma_f32_16x16x32_bf16 v[144:147], v[176:179], v[64:67], v[144:147]
    v_mfma_f32_16x16x32_bf16 v[148:151], v[200:203], v[64:67], v[148:151]
    v_mfma_f32_16x16x32_bf16 v[152:155], v[224:227], v[88:91], v[152:155]
    v_mfma_f32_16x16x32_bf16 v[136:139], v[180:183], v[44:47], v[136:139]
    v_mfma_f32_16x16x32_bf16 v[140:143], v[204:207], v[44:47], v[140:143]
    v_mfma_f32_16x16x32_bf16 v[144:147], v[180:183], v[68:71], v[144:147]
    v_mfma_f32_16x16x32_bf16 v[148:151], v[204:207], v[68:71], v[148:151]
    v_mfma_f32_16x16x32_bf16 v[152:155], v[228:231], v[92:95], v[152:155]
    s_waitcnt vmcnt(0)
    v_lshlrev_b32 v160, 16, v96
    v_and_b32 v161, 0xffff0000, v96
    v_lshlrev_b32 v162, 16, v97
    v_and_b32 v163, 0xffff0000, v97
    v_lshlrev_b32 v168, 16, v98
    v_and_b32 v169, 0xffff0000, v98
    v_lshlrev_b32 v170, 16, v99
    v_and_b32 v171, 0xffff0000, v99
    v_lshlrev_b32 v176, 16, v100
    v_and_b32 v177, 0xffff0000, v100
    v_lshlrev_b32 v178, 16, v101
    v_and_b32 v179, 0xffff0000, v101
    v_lshlrev_b32 v184, 16, v102
    v_and_b32 v185, 0xffff0000, v102
    v_lshlrev_b32 v186, 16, v103
    v_and_b32 v187, 0xffff0000, v103
    v_lshlrev_b32 v192, 16, v104
    v_and_b32 v193, 0xffff0000, v104
    v_lshlrev_b32 v194, 16, v105
    v_and_b32 v195, 0xffff0000, v105
    v_add_f32 v160, v160, v136
    v_add_f32 v161, v161, v137
    v_add_f32 v162, v162, v138
    v_add_f32 v163, v163, v139
    v_cvt_pk_bf16_f32 v96, v160, v161
    v_cvt_pk_bf16_f32 v97, v162, v163
    buffer_store_dwordx2 v[96:97], v113, s[24:27], s52 offen offset:0 sc1
    v_add_f32 v168, v168, v140
    v_add_f32 v169, v169, v141
    v_add_f32 v170, v170, v142
    v_add_f32 v171, v171, v143
    v_cvt_pk_bf16_f32 v98, v168, v169
    v_cvt_pk_bf16_f32 v99, v170, v171
    buffer_store_dwordx2 v[98:99], v113, s[24:27], s52 offen offset:1280 sc1
    v_add_f32 v176, v176, v144
    v_add_f32 v177, v177, v145
    v_add_f32 v178, v178, v146
    v_add_f32 v179, v179, v147
    v_cvt_pk_bf16_f32 v100, v176, v177
    v_cvt_pk_bf16_f32 v101, v178, v179
    buffer_store_dwordx2 v[100:101], v113, s[24:27], s52 offen offset:128 sc1
    v_add_f32 v184, v184, v148
    v_add_f32 v185, v185, v149
    v_add_f32 v186, v186, v150
    v_add_f32 v187, v187, v151
    v_cvt_pk_bf16_f32 v102, v184, v185
    v_cvt_pk_bf16_f32 v103, v186, v187
    buffer_store_dwordx2 v[102:103], v113, s[24:27], s52 offen offset:1408 sc1
    v_add_f32 v192, v192, v152
    v_add_f32 v193, v193, v153
    v_add_f32 v194, v194, v154
    v_add_f32 v195, v195, v155
    v_cvt_pk_bf16_f32 v104, v192, v193
    v_cvt_pk_bf16_f32 v105, v194, v195
    buffer_store_dwordx2 v[104:105], v113, s[24:27], s53 offen offset:0 sc1
    s_bfe_u32 s78, s40, 0x40003
    s_lshl_b32 s78, s78, 4
    s_lshr_b32 s91, s40, 7
    s_lshl_b32 s91, s91, 3
    s_add_u32 s78, s78, s91
    s_and_b32 s91, s40, 7
    s_add_u32 s78, s78, s91
    s_lshl_b32 s78, s78, 7
    s_add_u32 s78, s78, 19079168
    s_waitcnt vmcnt(0)
    s_barrier
    s_cmp_eq_u32 s3, 0
    s_cbranch_scc0 L_pb_61
    v_mov_b32 v110, s88
    s_mov_b64 exec, 1
    buffer_store_dword v110, v5, s[24:27], s78 offen sc0 sc1
    s_mov_b64 exec, -1
    s_nop 0
L_pb_61:
    s_endpgm
L_end_parallel_sum__spectral_gfnet__glu_gated_bilinear__prompt_kernel:
    s_endpgm
code_end:
.section .rodata,"a"
.p2align 6
.amdhsa_kernel parallel_sum__spectral_gfnet__glu_gated_bilinear__prompt_kernel
  .amdhsa_next_free_vgpr 256
  .amdhsa_next_free_sgpr 100
  .amdhsa_accum_offset 256
  .amdhsa_group_segment_fixed_size 0
  .amdhsa_kernarg_size 80
  .amdhsa_user_sgpr_count 2
  .amdhsa_user_sgpr_kernarg_segment_ptr 1
  .amdhsa_system_sgpr_workgroup_id_x 1
.end_amdhsa_kernel
```
